```python
import torch

def _softmax(x, axis=-1):
    return torch.softmax(x, dim=axis)
def _gelu(x):
    return torch.nn.functional.gelu(x, approximate="tanh")
def _silu(x):
    return torch.nn.functional.silu(x)
def _sigmoid(x):
    return torch.sigmoid(x)
def _layernorm(x, axis=-1, eps=1e-5):
    m = x.mean(dim=axis, keepdim=True)
    v = x.var(dim=axis, keepdim=True, unbiased=False)
    return (x - m) / torch.sqrt(v + eps)
def _scatter_add(tgt, idx, src, axis=0):
    return tgt.clone().index_add_(axis, idx, src)
def _segment_sum(src, seg, n):
    out = torch.zeros((n,) + src.shape[1:], dtype=src.dtype)
    return out.index_add_(0, seg, src)
def _pad(x, pw):
    flat = tuple(v for pair in reversed(pw) for v in pair)
    return torch.nn.functional.pad(x, flat)

kernel_name = 'gated_mix__softmax_full_mha__glu_gated_geglu__prompt'

def setup_inputs():

    _w = (lambda a: (lambda t: t.to(torch.bfloat16) if t.is_floating_point() else t)(torch.as_tensor(a)))
    def _A_setup():
        B, S, D = 1, 2048, 512
        return {
            "x": _w((lambda *s: torch.randn(*s, dtype=torch.bfloat16) * 0.05)(B, S, D)),
            "wqkv": _w((lambda *s: torch.randn(*s, dtype=torch.bfloat16) * 0.8)(D, 3 * D)),
            "wo": _w((lambda *s: torch.randn(*s, dtype=torch.bfloat16) * 0.05)(D, D)),
        }
    _A_in = _A_setup()

    def _B_setup():
        B, S, Dm, Df = 1, 2048, 512, 1376
        return {
            "x": _w((lambda *s: torch.randn(*s, dtype=torch.bfloat16) * 0.05)(B, S, Dm)),
            "w_gate": _w((lambda *s: torch.randn(*s, dtype=torch.bfloat16) * 3.2)(Dm, Df) * (Dm ** -0.5)),
            "w_up": _w((lambda *s: torch.randn(*s, dtype=torch.bfloat16) * 3.2)(Dm, Df) * (Dm ** -0.5)),
            "w_down": _w((lambda *s: torch.randn(*s, dtype=torch.bfloat16) * 3.2)(Df, Dm) * (Df ** -0.5)),
        }
    _B_in = _B_setup()

    return {
        "A_x": _A_in["x"],
        "A_wqkv": _A_in["wqkv"],
        "A_wo": _A_in["wo"],
        "B_x": _B_in["x"],
        "B_w_gate": _B_in["w_gate"],
        "B_w_up": _B_in["w_up"],
        "B_w_down": _B_in["w_down"],
        "gate_w": _w((lambda *s: torch.randn(*s, dtype=torch.bfloat16) * 0.05)(512) * 16.0),
    }

def reference(A_x, A_wqkv, A_wo, B_x, B_w_gate, B_w_up, B_w_down, gate_w):
    def _A_ref(x, wqkv, wo):
        B, S, D = x.shape
        H = 32; Dh = D // H
        qkv = (lambda x, *d: x.permute(*d))((x @ wqkv).reshape(B, S, 3, H, Dh), 2, 0, 3, 1, 4)
        q, k, v = qkv[0], qkv[1], qkv[2]
        scale = Dh ** -0.5
        scores = torch.einsum("bhqd,bhkd->bhqk", q, k) * scale
        p = _softmax(scores, axis=-1)
        o = torch.einsum("bhqk,bhkd->bhqd", p, v)
        return (lambda x, *d: x.permute(*d))(o, 0, 2, 1, 3).reshape(B, S, D) @ wo

    def _B_ref(x, w_gate, w_up, w_down):
        g = torch.einsum("bsd,df->bsf", x, w_gate)
        u = torch.einsum("bsd,df->bsf", x, w_up)
        h = _gelu(g) * u
        return torch.einsum("bsf,fd->bsd", h, w_down)

    x = A_x
    g = _sigmoid((x * gate_w).sum(-1, keepdims=True))
    a = _A_ref(x, A_wqkv, A_wo)
    b = _B_ref(x, B_w_gate, B_w_up, B_w_down)
    return g * a + (1 - g) * b
```

```asm
; @launch grid=(256,1,1) block=(512,1,1) lds=163840
.amdgcn_target "amdgcn-amd-amdhsa--gfx950"
.text
.globl gated_mix__softmax_full_mha__glu_gated_geglu__prompt_kernel
.p2align 8
.type gated_mix__softmax_full_mha__glu_gated_geglu__prompt_kernel,@function
gated_mix__softmax_full_mha__glu_gated_geglu__prompt_kernel:
    s_cmp_ge_u32 s2, 256
    s_cbranch_scc1 L_end
    s_load_dwordx2 s[4:5], s[0:1], 0
    s_load_dwordx2 s[8:9], s[0:1], 8
    s_load_dwordx2 s[40:41], s[0:1], 80
    s_load_dwordx2 s[36:37], s[0:1], 72
    v_lshrrev_b32 v1, 6, v0
    s_and_b32 s54, s2, 7
    v_readfirstlane_b32 s46, v1
    s_lshr_b32 s55, s2, 3
    v_and_b32 v0, 63, v0
    s_bfe_u32 s56, s54, 0x10001
    s_xor_b32 s54, s54, s56
    s_and_b32 s45, s54, 1
    s_lshl_b32 s45, s45, 3
    s_and_b32 s56, s55, 7
    s_add_u32 s45, s45, s56
    s_lshr_b32 s44, s54, 1
    s_lshl_b32 s44, s44, 2
    s_lshr_b32 s56, s55, 3
    s_add_u32 s44, s44, s56
    s_and_b32 s47, s46, 3
    s_add_u32 s48, s44, s45
    s_and_b32 s48, s48, 1
    s_lshl_b32 s48, s48, 2
    s_lshr_b32 s51, s54, 1
    s_lshl_b32 s56, s54, 1
    s_add_u32 s51, s51, s56
    s_mov_b32 s42, 268435456
    s_mov_b32 s43, 0x00020000
    s_mov_b32 s71, 1
    s_cmp_ge_u32 s46, 4
    s_cbranch_scc0 L_mwave
    s_setprio 2
    s_mov_b32 s6, 2097152
    s_mov_b32 s7, 0x00020000
    s_mov_b32 s10, 1572864
    s_mov_b32 s11, 0x00020000
    v_lshrrev_b32 v1, 3, v0
    v_and_b32 v2, 7, v0
    v_lshrrev_b32 v3, 4, v0
    s_lshl_b32 s61, s47, 5
    v_add_u32 v4, s61, v1
    v_xor_b32 v5, v2, v3
    v_lshlrev_b32 v5, 4, v5
    v_lshl_add_u32 v8, v4, 10, v5
    v_xor_b32 v9, 64, v8
    v_add_u32 v9, 8192, v9
    s_lshl_b32 s61, s47, 4
    v_add_u32 v4, s61, v1
    v_mul_u32_u24 v4, 3072, v4
    v_and_b32 v5, 1, v3
    v_lshlrev_b32 v5, 2, v5
    v_xor_b32 v5, v2, v5
    v_lshl_add_u32 v10, v5, 4, v4
    s_lshl_b32 s54, s45, 17
    s_and_b32 s55, s44, 1
    s_add_u32 s55, s55, 1
    s_lshl_b32 s55, s55, 10
    s_lshr_b32 s60, s44, 1
    s_lshl_b32 s60, s60, 7
    s_add_u32 s55, s55, s60
    s_lshl_b32 s57, s47, 12
    s_lshl_b32 s58, s47, 11
    s_add_u32 s60, s51, 0
    s_and_b32 s60, s60, 3
    s_add_u32 s60, s60, s48
    s_lshl_b32 s61, s60, 7
    s_add_u32 s61, s61, s54
    s_add_u32 m0, s57, 0
    s_nop 0
    s_waitcnt lgkmcnt(0)
    buffer_load_dwordx4 v8, s[4:7], s61 offen lds
    s_add_u32 m0, s57, 1024
    s_nop 0
    buffer_load_dwordx4 v9, s[4:7], s61 offen lds
    s_add_u32 m0, s57, 2048
    s_add_u32 s61, s61, 16384
    buffer_load_dwordx4 v8, s[4:7], s61 offen lds
    s_add_u32 m0, s57, 3072
    s_nop 0
    buffer_load_dwordx4 v9, s[4:7], s61 offen lds
    s_mul_i32 s61, s60, 196608
    s_add_u32 m0, s58, 16384
    s_add_u32 s61, s61, s55
    buffer_load_dwordx4 v10, s[8:11], s61 offen lds
    s_add_u32 m0, s58, 17408
    s_add_u32 s61, s61, 24576
    buffer_load_dwordx4 v10, s[8:11], s61 offen lds
    s_lshr_b32 s49, s2, 5
    s_lshr_b32 s61, s47, 1
    s_or_b32 s49, s49, s61
    s_cbranch_scc1 L_noreset_1
    s_lshl_b32 s61, s2, 1
    s_add_u32 s61, s61, s47
    s_mul_i32 s61, s61, 1408
    s_add_u32 s61, s61, 12582912
    s_mov_b32 s69, 0
    s_atomic_and s69, s[40:41], s61 offset:0
    s_atomic_and s69, s[40:41], s61 offset:128
    s_atomic_and s69, s[40:41], s61 offset:256
    s_atomic_and s69, s[40:41], s61 offset:384
    s_atomic_and s69, s[40:41], s61 offset:512
    s_atomic_and s69, s[40:41], s61 offset:640
    s_atomic_and s69, s[40:41], s61 offset:768
    s_atomic_and s69, s[40:41], s61 offset:896
    s_atomic_and s69, s[40:41], s61 offset:1024
    s_atomic_and s69, s[40:41], s61 offset:1152
    s_atomic_and s69, s[40:41], s61 offset:1280
L_noreset_1:
    s_add_u32 s60, s51, 1
    s_and_b32 s60, s60, 3
    s_add_u32 s60, s60, s48
    s_lshl_b32 s61, s60, 7
    s_add_u32 s61, s61, s54
    s_add_u32 m0, s57, 24576
    s_nop 0
    buffer_load_dwordx4 v8, s[4:7], s61 offen lds
    s_add_u32 m0, s57, 25600
    s_nop 0
    buffer_load_dwordx4 v9, s[4:7], s61 offen lds
    s_add_u32 m0, s57, 26624
    s_add_u32 s61, s61, 16384
    buffer_load_dwordx4 v8, s[4:7], s61 offen lds
    s_add_u32 m0, s57, 27648
    s_nop 0
    buffer_load_dwordx4 v9, s[4:7], s61 offen lds
    s_mul_i32 s61, s60, 196608
    s_add_u32 m0, s58, 40960
    s_add_u32 s61, s61, s55
    buffer_load_dwordx4 v10, s[8:11], s61 offen lds
    s_add_u32 m0, s58, 41984
    s_add_u32 s61, s61, 24576
    buffer_load_dwordx4 v10, s[8:11], s61 offen lds
    v_lshrrev_b32 v4, 2, v0
    s_lshl_b32 s61, s47, 4
    v_add_u32 v4, s61, v4
    v_mul_u32_u24 v4, 3072, v4
    v_and_b32 v5, 3, v0
    v_lshl_add_u32 v11, v5, 4, v4
    s_lshl_b32 s56, s44, 6
    s_lshl_b32 s59, s47, 10
    s_mov_b32 s52, 0x0000ffff
    s_mov_b32 s53, 0x0000ffff
    v_lshrrev_b32 v4, 1, v0
    v_mul_u32_u24 v4, 3072, v4
    v_and_b32 v5, 1, v0
    v_lshl_add_u32 v4, v5, 7, v4
    s_lshr_b32 s61, s2, 3
    s_lshl_b32 s61, s61, 2
    s_add_u32 s61, s61, s47
    s_mul_i32 s61, s61, 12288
    s_lshr_b32 s60, s44, 2
    s_lshl_b32 s60, s60, 8
    s_add_u32 s61, s61, s60
    s_mov_b32 m0, 158272
    s_mov_b64 exec, 255
    buffer_load_dword v4, s[8:11], s61 offen  lds
    s_mov_b64 exec, -1
    s_setprio 0
    s_and_b32 s62, s46, 1
    s_lshr_b32 s63, s47, 1
    v_lshrrev_b32 v5, 5, v0
    s_and_b32 s65, s45, 14
    s_add_u32 s65, s65, s63
    s_and_b32 s65, s65, 15
    s_mov_b32 s66, 8
    v_lshlrev_b32 v13, 4, v0
    v_and_b32 v14, 15, v0
    v_lshlrev_b32 v14, 4, v14
    v_lshl_add_u32 v14, v5, 8, v14
    s_lshl_b32 s67, s62, 12
    s_add_u32 s67, s67, 131072
    v_add_u32 v6, s67, v13
    s_lshl_b32 s67, s63, 11
    v_add_u32 v6, s67, v6
    v_mov_b32 v12, 0xdddddddd
    v_mov_b32 v7, 1
    v_and_b32 v4, 0x1b, v0
    v_cmp_eq_u32 vcc, 16, v4
    v_mov_b32 v4, 0x3f803f80
    s_mul_i32 s67, s47, 4608
    v_cndmask_b32 v4, 0, v4, vcc
    s_add_u32 s67, s67, 139776
    v_lshl_add_u32 v2, v0, 4, s67
    v_lshl_add_u32 v3, v0, 2, s67
    s_lshl_b32 s67, s62, 2
    s_add_u32 s67, s67, 158216
    v_mov_b32 v1, s67
    s_lshl_b32 s67, s47, 2
    s_add_u32 s67, s67, 158240
    v_mov_b32 v15, s67
    v_mov_b32 v132, v4
    v_mov_b32 v133, v4
    v_mov_b32 v134, v4
    v_mov_b32 v135, v4
    v_mov_b32 v136, v4
    v_mov_b32 v137, v4
    v_mov_b32 v138, v4
    v_mov_b32 v139, v4
    v_mov_b32 v144, v4
    v_mov_b32 v145, v4
    v_mov_b32 v146, v4
    v_mov_b32 v147, v4
    v_mov_b32 v148, v4
    v_mov_b32 v149, v4
    v_mov_b32 v150, v4
    v_mov_b32 v151, v4
    v_mov_b32 v156, v4
    v_mov_b32 v157, v4
    v_mov_b32 v158, v4
    v_mov_b32 v159, v4
    v_mov_b32 v160, v4
    v_mov_b32 v161, v4
    v_mov_b32 v162, v4
    v_mov_b32 v163, v4
    v_mov_b32 v168, v4
    v_mov_b32 v169, v4
    v_mov_b32 v170, v4
    v_mov_b32 v171, v4
    v_mov_b32 v172, v4
    v_mov_b32 v173, v4
    v_mov_b32 v174, v4
    v_mov_b32 v175, v4
    v_mov_b32 v16, 0
    v_mov_b32 v17, 0
    v_mov_b32 v18, 0
    v_mov_b32 v19, 0
    v_mov_b32 v20, 0
    v_mov_b32 v21, 0
    v_mov_b32 v22, 0
    v_mov_b32 v23, 0
    v_mov_b32 v24, 0
    v_mov_b32 v25, 0
    v_mov_b32 v26, 0
    v_mov_b32 v27, 0
    v_mov_b32 v28, 0
    v_mov_b32 v29, 0
    v_mov_b32 v30, 0
    v_mov_b32 v31, 0
    v_mov_b32 v32, 0
    v_mov_b32 v33, 0
    v_mov_b32 v34, 0
    v_mov_b32 v35, 0
    v_mov_b32 v36, 0
    v_mov_b32 v37, 0
    v_mov_b32 v38, 0
    v_mov_b32 v39, 0
    v_mov_b32 v40, 0
    v_mov_b32 v41, 0
    v_mov_b32 v42, 0
    v_mov_b32 v43, 0
    v_mov_b32 v44, 0
    v_mov_b32 v45, 0
    v_mov_b32 v46, 0
    v_mov_b32 v47, 0
    v_mov_b32 v48, 0
    v_mov_b32 v49, 0
    v_mov_b32 v50, 0
    v_mov_b32 v51, 0
    v_mov_b32 v52, 0
    v_mov_b32 v53, 0
    v_mov_b32 v54, 0
    v_mov_b32 v55, 0
    v_mov_b32 v56, 0
    v_mov_b32 v57, 0
    v_mov_b32 v58, 0
    v_mov_b32 v59, 0
    v_mov_b32 v60, 0
    v_mov_b32 v61, 0
    v_mov_b32 v62, 0
    v_mov_b32 v63, 0
    v_mov_b32 v64, 0
    v_mov_b32 v65, 0
    v_mov_b32 v66, 0
    v_mov_b32 v67, 0
    v_mov_b32 v68, 0
    v_mov_b32 v69, 0
    v_mov_b32 v70, 0
    v_mov_b32 v71, 0
    v_mov_b32 v72, 0
    v_mov_b32 v73, 0
    v_mov_b32 v74, 0
    v_mov_b32 v75, 0
    v_mov_b32 v76, 0
    v_mov_b32 v77, 0
    v_mov_b32 v78, 0
    v_mov_b32 v79, 0
    s_setprio 2
    s_cmp_lg_u32 s49, 0
    s_cbranch_scc1 L_nogo_2
    s_lshl_b32 s61, s47, 7
    s_waitcnt lgkmcnt(0)
    s_atomic_add s71, s[36:37], s61
L_nogo_2:
    s_add_u32 s60, s51, 2
    s_and_b32 s60, s60, 3
    s_add_u32 s60, s60, s48
    s_lshl_b32 s61, s60, 7
    s_add_u32 s61, s61, s54
    s_add_u32 m0, s57, 49152
    s_nop 0
    buffer_load_dwordx4 v8, s[4:7], s61 offen lds
    s_add_u32 m0, s57, 50176
    s_nop 0
    buffer_load_dwordx4 v9, s[4:7], s61 offen lds
    s_add_u32 m0, s57, 51200
    s_add_u32 s61, s61, 16384
    buffer_load_dwordx4 v8, s[4:7], s61 offen lds
    s_add_u32 m0, s57, 52224
    s_nop 0
    buffer_load_dwordx4 v9, s[4:7], s61 offen lds
    s_mul_i32 s61, s60, 196608
    s_add_u32 m0, s58, 65536
    s_add_u32 s61, s61, s55
    buffer_load_dwordx4 v10, s[8:11], s61 offen lds
    s_add_u32 m0, s58, 66560
    s_add_u32 s61, s61, 24576
    buffer_load_dwordx4 v10, s[8:11], s61 offen lds
    s_waitcnt vmcnt(13)
    s_barrier
    s_add_u32 s60, s51, 3
    s_and_b32 s60, s60, 3
    s_add_u32 s60, s60, s48
    s_lshl_b32 s61, s60, 7
    s_add_u32 s61, s61, s54
    s_add_u32 m0, s57, 73728
    s_nop 0
    buffer_load_dwordx4 v8, s[4:7], s61 offen lds
    s_add_u32 m0, s57, 74752
    s_nop 0
    buffer_load_dwordx4 v9, s[4:7], s61 offen lds
    s_add_u32 m0, s57, 75776
    s_add_u32 s61, s61, 16384
    buffer_load_dwordx4 v8, s[4:7], s61 offen lds
    s_add_u32 m0, s57, 76800
    s_nop 0
    buffer_load_dwordx4 v9, s[4:7], s61 offen lds
    s_mul_i32 s61, s60, 196608
    s_add_u32 m0, s58, 90112
    s_add_u32 s61, s61, s55
    buffer_load_dwordx4 v10, s[8:11], s61 offen lds
    s_add_u32 m0, s58, 91136
    s_add_u32 s61, s61, 24576
    buffer_load_dwordx4 v10, s[8:11], s61 offen lds
    s_waitcnt vmcnt(13)
    s_barrier
    s_add_u32 s60, s51, 0
    s_and_b32 s60, s60, 3
    s_add_u32 s60, s60, s48
    s_xor_b32 s60, s60, 4
    s_lshl_b32 s61, s60, 7
    s_add_u32 s61, s61, s54
    s_add_u32 m0, s57, 0
    s_nop 0
    buffer_load_dwordx4 v8, s[4:7], s61 offen lds
    s_add_u32 m0, s57, 1024
    s_nop 0
    buffer_load_dwordx4 v9, s[4:7], s61 offen lds
    s_add_u32 m0, s57, 2048
    s_add_u32 s61, s61, 16384
    buffer_load_dwordx4 v8, s[4:7], s61 offen lds
    s_add_u32 m0, s57, 3072
    s_nop 0
    buffer_load_dwordx4 v9, s[4:7], s61 offen lds
    s_mul_i32 s61, s60, 196608
    s_add_u32 m0, s58, 16384
    s_add_u32 s61, s61, s55
    buffer_load_dwordx4 v10, s[8:11], s61 offen lds
    s_add_u32 m0, s58, 17408
    s_add_u32 s61, s61, 24576
    buffer_load_dwordx4 v10, s[8:11], s61 offen lds
    s_waitcnt vmcnt(12)
    s_barrier
    s_add_u32 s60, s51, 1
    s_and_b32 s60, s60, 3
    s_add_u32 s60, s60, s48
    s_xor_b32 s60, s60, 4
    s_lshl_b32 s61, s60, 7
    s_add_u32 s61, s61, s54
    s_add_u32 m0, s57, 24576
    s_nop 0
    buffer_load_dwordx4 v8, s[4:7], s61 offen lds
    s_add_u32 m0, s57, 25600
    s_nop 0
    buffer_load_dwordx4 v9, s[4:7], s61 offen lds
    s_add_u32 m0, s57, 26624
    s_add_u32 s61, s61, 16384
    buffer_load_dwordx4 v8, s[4:7], s61 offen lds
    s_add_u32 m0, s57, 27648
    s_nop 0
    buffer_load_dwordx4 v9, s[4:7], s61 offen lds
    s_mul_i32 s61, s60, 196608
    s_add_u32 m0, s58, 40960
    s_add_u32 s61, s61, s55
    buffer_load_dwordx4 v10, s[8:11], s61 offen lds
    s_add_u32 m0, s58, 41984
    s_add_u32 s61, s61, 24576
    buffer_load_dwordx4 v10, s[8:11], s61 offen lds
    s_waitcnt vmcnt(12)
    s_barrier
    s_add_u32 s60, s51, 2
    s_and_b32 s60, s60, 3
    s_add_u32 s60, s60, s48
    s_xor_b32 s60, s60, 4
    s_lshl_b32 s61, s60, 7
    s_add_u32 s61, s61, s54
    s_add_u32 m0, s57, 49152
    s_nop 0
    buffer_load_dwordx4 v8, s[4:7], s61 offen lds
    s_add_u32 m0, s57, 50176
    s_nop 0
    buffer_load_dwordx4 v9, s[4:7], s61 offen lds
    s_add_u32 m0, s57, 51200
    s_add_u32 s61, s61, 16384
    buffer_load_dwordx4 v8, s[4:7], s61 offen lds
    s_add_u32 m0, s57, 52224
    s_nop 0
    buffer_load_dwordx4 v9, s[4:7], s61 offen lds
    s_mul_i32 s61, s60, 196608
    s_add_u32 m0, s58, 65536
    s_add_u32 s61, s61, s55
    buffer_load_dwordx4 v10, s[8:11], s61 offen lds
    s_add_u32 m0, s58, 66560
    s_add_u32 s61, s61, 24576
    buffer_load_dwordx4 v10, s[8:11], s61 offen lds
    s_waitcnt vmcnt(12)
    s_barrier
    s_add_u32 s60, s51, 3
    s_and_b32 s60, s60, 3
    s_add_u32 s60, s60, s48
    s_xor_b32 s60, s60, 4
    s_lshl_b32 s61, s60, 7
    s_add_u32 s61, s61, s54
    s_add_u32 m0, s57, 73728
    s_nop 0
    buffer_load_dwordx4 v8, s[4:7], s61 offen lds
    s_add_u32 m0, s57, 74752
    s_nop 0
    buffer_load_dwordx4 v9, s[4:7], s61 offen lds
    s_add_u32 m0, s57, 75776
    s_add_u32 s61, s61, 16384
    buffer_load_dwordx4 v8, s[4:7], s61 offen lds
    s_add_u32 m0, s57, 76800
    s_nop 0
    buffer_load_dwordx4 v9, s[4:7], s61 offen lds
    s_mul_i32 s61, s60, 196608
    s_add_u32 m0, s58, 90112
    s_add_u32 s61, s61, s55
    buffer_load_dwordx4 v10, s[8:11], s61 offen lds
    s_add_u32 m0, s58, 91136
    s_add_u32 s61, s61, 24576
    buffer_load_dwordx4 v10, s[8:11], s61 offen lds
    s_waitcnt vmcnt(12)
    s_barrier
    s_add_u32 s60, s51, 0
    s_and_b32 s60, s60, 3
    s_add_u32 s60, s60, s48
    s_mul_i32 s61, s60, 196608
    s_add_u32 m0, s59, 98304
    s_add_u32 s61, s61, s56
    buffer_load_dwordx4 v11, s[8:11], s61 offen lds
    s_add_u32 s60, s51, 1
    s_and_b32 s60, s60, 3
    s_add_u32 s60, s60, s48
    s_mul_i32 s61, s60, 196608
    s_add_u32 m0, s59, 102400
    s_add_u32 s61, s61, s56
    buffer_load_dwordx4 v11, s[8:11], s61 offen lds
    s_add_u32 s60, s51, 2
    s_and_b32 s60, s60, 3
    s_add_u32 s60, s60, s48
    s_mul_i32 s61, s60, 196608
    s_add_u32 m0, s59, 106496
    s_add_u32 s61, s61, s56
    buffer_load_dwordx4 v11, s[8:11], s61 offen lds
    s_add_u32 s60, s51, 3
    s_and_b32 s60, s60, 3
    s_add_u32 s60, s60, s48
    s_mul_i32 s61, s60, 196608
    s_add_u32 m0, s59, 110592
    s_add_u32 s61, s61, s56
    buffer_load_dwordx4 v11, s[8:11], s61 offen lds
    s_waitcnt vmcnt(10)
    s_barrier
    s_add_u32 s60, s51, 0
    s_and_b32 s60, s60, 3
    s_add_u32 s60, s60, s48
    s_xor_b32 s60, s60, 4
    s_mul_i32 s61, s60, 196608
    s_add_u32 m0, s59, 114688
    s_add_u32 s61, s61, s56
    buffer_load_dwordx4 v11, s[8:11], s61 offen lds
    s_add_u32 s60, s51, 1
    s_and_b32 s60, s60, 3
    s_add_u32 s60, s60, s48
    s_xor_b32 s60, s60, 4
    s_mul_i32 s61, s60, 196608
    s_add_u32 m0, s59, 118784
    s_add_u32 s61, s61, s56
    buffer_load_dwordx4 v11, s[8:11], s61 offen lds
    s_add_u32 s60, s51, 2
    s_and_b32 s60, s60, 3
    s_add_u32 s60, s60, s48
    s_xor_b32 s60, s60, 4
    s_mul_i32 s61, s60, 196608
    s_add_u32 m0, s59, 122880
    s_add_u32 s61, s61, s56
    buffer_load_dwordx4 v11, s[8:11], s61 offen lds
    s_add_u32 s60, s51, 3
    s_and_b32 s60, s60, 3
    s_add_u32 s60, s60, s48
    s_xor_b32 s60, s60, 4
    s_mul_i32 s61, s60, 196608
    s_add_u32 m0, s59, 126976
    s_add_u32 s61, s61, s56
    buffer_load_dwordx4 v11, s[8:11], s61 offen lds
    s_waitcnt vmcnt(8)
    s_barrier
    s_waitcnt vmcnt(0)
    s_barrier
    s_lshl_b32 s54, s44, 1
    s_add_u32 s54, s54, s62
    s_lshl_b32 s54, s54, 17
    s_lshr_b32 s55, s44, 1
    s_lshl_b32 s55, s55, 11
    s_add_u32 s55, s55, 12582912
    s_lshl_b32 s64, s65, 13
    s_add_u32 s64, s64, s54
    s_lshl_b32 s68, s65, 7
    s_add_u32 s68, s68, s55
    v_mov_b32 v5, 158208
    ds_read_b32 v4, v5 offset:48
    s_waitcnt lgkmcnt(0)
    v_cmp_gt_u32 vcc, 16, v4
    s_cbranch_vccz L_ldone_4
    s_mov_b32 s70, 1000000
L_lspin_3:
    ds_read_b32 v4, v5 offset:48
    s_waitcnt lgkmcnt(0)
    v_cmp_gt_u32 vcc, 16, v4
    s_cbranch_vccz L_ldone_4
    s_sub_u32 s70, s70, 1
    s_cmp_lg_u32 s70, 0
    s_cbranch_scc1 L_lspin_3
L_ldone_4:
    s_mov_b32 s70, 200000
L_spoll_5:
    s_mov_b32 s69, 0
    s_atomic_add s69, s[40:41], s68 glc
    s_waitcnt lgkmcnt(0)
    s_cmp_ge_u32 s69, 8
    s_cbranch_scc1 L_sdone_6
    s_sub_u32 s70, s70, 1
    s_cmp_lg_u32 s70, 0
    s_cbranch_scc1 L_spoll_5
L_sdone_6:
    buffer_load_dwordx4 v[128:131], v13, s[40:43], s64 offen sc1
    s_mov_b64 exec, s[52:53]
    buffer_load_dwordx4 v[132:135], v14, s[40:43], s64 offen offset:1024 sc1
    buffer_load_dwordx4 v[136:139], v14, s[40:43], s64 offen offset:1536 sc1
    s_mov_b64 exec, -1
    s_add_u32 s64, s64, 2048
    buffer_load_dwordx4 v[140:143], v13, s[40:43], s64 offen sc1
    s_mov_b64 exec, s[52:53]
    buffer_load_dwordx4 v[144:147], v14, s[40:43], s64 offen offset:1024 sc1
    buffer_load_dwordx4 v[148:151], v14, s[40:43], s64 offen offset:1536 sc1
    s_mov_b64 exec, -1
    s_add_u32 s64, s64, 2048
    buffer_load_dwordx4 v[152:155], v13, s[40:43], s64 offen sc1
    s_mov_b64 exec, s[52:53]
    buffer_load_dwordx4 v[156:159], v14, s[40:43], s64 offen offset:1024 sc1
    buffer_load_dwordx4 v[160:163], v14, s[40:43], s64 offen offset:1536 sc1
    s_mov_b64 exec, -1
    s_add_u32 s64, s64, 2048
    s_mov_b64 exec, 1
    ds_add_u32 v5, v7 offset:20
    s_mov_b64 exec, -1
    ds_read_b32 v4, v5 offset:16
    s_waitcnt lgkmcnt(0)
    v_cmp_gt_u32 vcc, 16, v4
    s_cbranch_vccz L_ldone_8
    s_mov_b32 s70, 1000000
L_lspin_7:
    ds_read_b32 v4, v5 offset:16
    s_waitcnt lgkmcnt(0)
    v_cmp_gt_u32 vcc, 16, v4
    s_cbranch_vccz L_ldone_8
    s_sub_u32 s70, s70, 1
    s_cmp_lg_u32 s70, 0
    s_cbranch_scc1 L_lspin_7
L_ldone_8:
    v_xor_b32 v4, 0x800, v6
    ds_read_b128 v[112:115], v4 offset:0
    ds_read_b128 v[116:119], v4 offset:1024
    ds_read_b128 v[120:123], v6 offset:0
    ds_read_b128 v[124:127], v6 offset:1024
    s_add_u32 s65, s65, 2
    s_and_b32 s65, s65, 15
    s_lshl_b32 s68, s65, 7
    s_add_u32 s68, s68, s55
    s_mov_b32 s69, 0
    s_waitcnt lgkmcnt(0)
    s_mov_b64 exec, 1
    ds_add_u32 v5, v7 offset:24
    s_mov_b64 exec, -1
    s_atomic_add s69, s[40:41], s68 glc
    s_waitcnt vmcnt(6)
    v_mfma_f32_32x32x16_bf16 v[80:95], v[128:131], v[112:115], 4.0
    s_nop 11
    v_exp_f32 v80, v80
    v_exp_f32 v81, v81
.p2align 6
L_attn:
    v_exp_f32 v82, v82
    v_exp_f32 v83, v83
    v_exp_f32 v84, v84
    v_mfma_f32_32x32x16_bf16 v[96:111], v[128:131], v[116:119], 4.0
    buffer_load_dwordx4 v[164:167], v13, s[40:43], s64 offen sc1
    v_exp_f32 v85, v85
    v_exp_f32 v86, v86
    v_exp_f32 v87, v87
    v_exp_f32 v88, v88
    v_exp_f32 v89, v89
    v_smfmac_f32_32x32x32_bf16 v[16:31], v[132:135], v[80:87], v12
    v_exp_f32 v90, v90
    v_exp_f32 v91, v91
    v_exp_f32 v92, v92
    v_exp_f32 v93, v93
    v_exp_f32 v94, v94
    v_exp_f32 v95, v95
    v_exp_f32 v96, v96
    v_exp_f32 v97, v97
    v_smfmac_f32_32x32x32_bf16 v[16:31], v[136:139], v[88:95], v12
    v_exp_f32 v98, v98
    v_exp_f32 v99, v99
    v_exp_f32 v100, v100
    v_mfma_f32_32x32x16_bf16 v[80:95], v[128:131], v[120:123], 4.0
    v_exp_f32 v101, v101
    v_exp_f32 v102, v102
    v_exp_f32 v103, v103
    v_exp_f32 v104, v104
    v_exp_f32 v105, v105
    v_smfmac_f32_32x32x32_bf16 v[32:47], v[132:135], v[96:103], v12
    s_mov_b64 exec, s[52:53]
    buffer_load_dwordx4 v[168:171], v14, s[40:43], s64 offen offset:1024 sc1
    buffer_load_dwordx4 v[172:175], v14, s[40:43], s64 offen offset:1536 sc1
    s_mov_b64 exec, -1
    v_exp_f32 v106, v106
    v_exp_f32 v107, v107
    v_exp_f32 v108, v108
    v_exp_f32 v109, v109
    v_exp_f32 v110, v110
    v_exp_f32 v111, v111
    v_exp_f32 v80, v80
    v_exp_f32 v81, v81
    v_smfmac_f32_32x32x32_bf16 v[32:47], v[136:139], v[104:111], v12
    s_lshl_b32 s64, s65, 13
    s_add_u32 s64, s64, s54
    v_exp_f32 v82, v82
    v_exp_f32 v83, v83
    v_exp_f32 v84, v84
    v_mfma_f32_32x32x16_bf16 v[96:111], v[128:131], v[124:127], 4.0
    v_exp_f32 v85, v85
    v_exp_f32 v86, v86
    v_exp_f32 v87, v87
    v_exp_f32 v88, v88
    v_exp_f32 v89, v89
    v_smfmac_f32_32x32x32_bf16 v[48:63], v[132:135], v[80:87], v12
    s_cmp_eq_u32 s66, 1
    s_cselect_b32 s64, 536870912, s64
    v_exp_f32 v90, v90
    v_exp_f32 v91, v91
    v_exp_f32 v92, v92
    v_exp_f32 v93, v93
    v_exp_f32 v94, v94
    v_exp_f32 v95, v95
    v_exp_f32 v96, v96
    v_exp_f32 v97, v97
    v_smfmac_f32_32x32x32_bf16 v[48:63], v[136:139], v[88:95], v12
    s_waitcnt vmcnt(6)
    v_exp_f32 v98, v98
    v_exp_f32 v99, v99
    v_exp_f32 v100, v100
    v_mfma_f32_32x32x16_bf16 v[80:95], v[140:143], v[112:115], 4.0
    s_waitcnt lgkmcnt(0)
    v_exp_f32 v101, v101
    v_exp_f32 v102, v102
    v_exp_f32 v103, v103
    v_exp_f32 v104, v104
    v_exp_f32 v105, v105
    v_smfmac_f32_32x32x32_bf16 v[64:79], v[132:135], v[96:103], v12
    s_cmp_lt_u32 s69, 8
    s_cbranch_scc1 L_kv_wait
L_kv_ok:
    v_exp_f32 v106, v106
    v_exp_f32 v107, v107
    v_exp_f32 v108, v108
    v_exp_f32 v109, v109
    v_exp_f32 v110, v110
    v_exp_f32 v111, v111
    v_exp_f32 v80, v80
    v_exp_f32 v81, v81
    v_smfmac_f32_32x32x32_bf16 v[64:79], v[136:139], v[104:111], v12
    s_cmp_eq_u32 s66, 5
    s_cbranch_scc1 L_rdv
L_rdv_ok:
    v_exp_f32 v82, v82
    v_exp_f32 v83, v83
    v_exp_f32 v84, v84
    v_mfma_f32_32x32x16_bf16 v[96:111], v[140:143], v[116:119], 4.0
    buffer_load_dwordx4 v[128:131], v13, s[40:43], s64 offen sc1
    v_exp_f32 v85, v85
    v_exp_f32 v86, v86
    v_exp_f32 v87, v87
    v_exp_f32 v88, v88
    v_exp_f32 v89, v89
    v_smfmac_f32_32x32x32_bf16 v[16:31], v[144:147], v[80:87], v12
    v_exp_f32 v90, v90
    v_exp_f32 v91, v91
    v_exp_f32 v92, v92
    v_exp_f32 v93, v93
    v_exp_f32 v94, v94
    v_exp_f32 v95, v95
    v_exp_f32 v96, v96
    v_exp_f32 v97, v97
    v_smfmac_f32_32x32x32_bf16 v[16:31], v[148:151], v[88:95], v12
    v_exp_f32 v98, v98
    v_exp_f32 v99, v99
    v_exp_f32 v100, v100
    v_mfma_f32_32x32x16_bf16 v[80:95], v[140:143], v[120:123], 4.0
    v_exp_f32 v101, v101
    v_exp_f32 v102, v102
    v_exp_f32 v103, v103
    v_exp_f32 v104, v104
    v_exp_f32 v105, v105
    v_smfmac_f32_32x32x32_bf16 v[32:47], v[144:147], v[96:103], v12
    s_mov_b64 exec, s[52:53]
    buffer_load_dwordx4 v[132:135], v14, s[40:43], s64 offen offset:1024 sc1
    buffer_load_dwordx4 v[136:139], v14, s[40:43], s64 offen offset:1536 sc1
    s_mov_b64 exec, -1
    v_exp_f32 v106, v106
    v_exp_f32 v107, v107
    v_exp_f32 v108, v108
    v_exp_f32 v109, v109
    v_exp_f32 v110, v110
    v_exp_f32 v111, v111
    v_exp_f32 v80, v80
    v_exp_f32 v81, v81
    v_smfmac_f32_32x32x32_bf16 v[32:47], v[148:151], v[104:111], v12
    s_add_u32 s65, s65, 2
    s_and_b32 s65, s65, 15
    v_exp_f32 v82, v82
    v_exp_f32 v83, v83
    v_exp_f32 v84, v84
    v_mfma_f32_32x32x16_bf16 v[96:111], v[140:143], v[124:127], 4.0
    s_add_u32 s64, s64, 2048
    v_exp_f32 v85, v85
    v_exp_f32 v86, v86
    v_exp_f32 v87, v87
    v_exp_f32 v88, v88
    v_exp_f32 v89, v89
    v_smfmac_f32_32x32x32_bf16 v[48:63], v[144:147], v[80:87], v12
    s_lshl_b32 s68, s65, 7
    s_add_u32 s68, s68, s55
    v_exp_f32 v90, v90
    v_exp_f32 v91, v91
    v_exp_f32 v92, v92
    v_exp_f32 v93, v93
    v_exp_f32 v94, v94
    v_exp_f32 v95, v95
    v_exp_f32 v96, v96
    v_exp_f32 v97, v97
    v_smfmac_f32_32x32x32_bf16 v[48:63], v[148:151], v[88:95], v12
    s_waitcnt vmcnt(6)
    v_exp_f32 v98, v98
    v_exp_f32 v99, v99
    v_exp_f32 v100, v100
    v_mfma_f32_32x32x16_bf16 v[80:95], v[152:155], v[112:115], 4.0
    v_exp_f32 v101, v101
    v_exp_f32 v102, v102
    v_exp_f32 v103, v103
    v_exp_f32 v104, v104
    v_exp_f32 v105, v105
    v_smfmac_f32_32x32x32_bf16 v[64:79], v[144:147], v[96:103], v12
    v_exp_f32 v106, v106
    v_exp_f32 v107, v107
    v_exp_f32 v108, v108
    v_exp_f32 v109, v109
    v_exp_f32 v110, v110
    v_exp_f32 v111, v111
    v_exp_f32 v80, v80
    v_exp_f32 v81, v81
    v_smfmac_f32_32x32x32_bf16 v[64:79], v[148:151], v[104:111], v12
    v_exp_f32 v82, v82
    v_exp_f32 v83, v83
    v_exp_f32 v84, v84
    v_mfma_f32_32x32x16_bf16 v[96:111], v[152:155], v[116:119], 4.0
    buffer_load_dwordx4 v[140:143], v13, s[40:43], s64 offen sc1
    v_exp_f32 v85, v85
    v_exp_f32 v86, v86
    v_exp_f32 v87, v87
    v_exp_f32 v88, v88
    v_exp_f32 v89, v89
    v_smfmac_f32_32x32x32_bf16 v[16:31], v[156:159], v[80:87], v12
    v_exp_f32 v90, v90
    v_exp_f32 v91, v91
    v_exp_f32 v92, v92
    v_exp_f32 v93, v93
    v_exp_f32 v94, v94
    v_exp_f32 v95, v95
    v_exp_f32 v96, v96
    v_exp_f32 v97, v97
    v_smfmac_f32_32x32x32_bf16 v[16:31], v[160:163], v[88:95], v12
    v_exp_f32 v98, v98
    v_exp_f32 v99, v99
    v_exp_f32 v100, v100
    v_mfma_f32_32x32x16_bf16 v[80:95], v[152:155], v[120:123], 4.0
    v_exp_f32 v101, v101
    v_exp_f32 v102, v102
    v_exp_f32 v103, v103
    v_exp_f32 v104, v104
    v_exp_f32 v105, v105
    v_smfmac_f32_32x32x32_bf16 v[32:47], v[156:159], v[96:103], v12
    s_mov_b64 exec, s[52:53]
    buffer_load_dwordx4 v[144:147], v14, s[40:43], s64 offen offset:1024 sc1
    buffer_load_dwordx4 v[148:151], v14, s[40:43], s64 offen offset:1536 sc1
    s_mov_b64 exec, -1
    v_exp_f32 v106, v106
    v_exp_f32 v107, v107
    v_exp_f32 v108, v108
    v_exp_f32 v109, v109
    v_exp_f32 v110, v110
    v_exp_f32 v111, v111
    v_exp_f32 v80, v80
    v_exp_f32 v81, v81
    v_smfmac_f32_32x32x32_bf16 v[32:47], v[160:163], v[104:111], v12
    s_mov_b32 s69, 0
    s_atomic_add s69, s[40:41], s68 glc
    v_exp_f32 v82, v82
    v_exp_f32 v83, v83
    v_exp_f32 v84, v84
    v_mfma_f32_32x32x16_bf16 v[96:111], v[152:155], v[124:127], 4.0
    s_add_u32 s64, s64, 2048
    v_exp_f32 v85, v85
    v_exp_f32 v86, v86
    v_exp_f32 v87, v87
    v_exp_f32 v88, v88
    v_exp_f32 v89, v89
    v_smfmac_f32_32x32x32_bf16 v[48:63], v[156:159], v[80:87], v12
    v_exp_f32 v90, v90
    v_exp_f32 v91, v91
    v_exp_f32 v92, v92
    v_exp_f32 v93, v93
    v_exp_f32 v94, v94
    v_exp_f32 v95, v95
    v_exp_f32 v96, v96
    v_exp_f32 v97, v97
    v_smfmac_f32_32x32x32_bf16 v[48:63], v[160:163], v[88:95], v12
    s_waitcnt vmcnt(6)
    v_exp_f32 v98, v98
    v_exp_f32 v99, v99
    v_exp_f32 v100, v100
    v_mfma_f32_32x32x16_bf16 v[80:95], v[164:167], v[112:115], 4.0
    v_exp_f32 v101, v101
    v_exp_f32 v102, v102
    v_exp_f32 v103, v103
    v_exp_f32 v104, v104
    v_exp_f32 v105, v105
    v_smfmac_f32_32x32x32_bf16 v[64:79], v[156:159], v[96:103], v12
    v_exp_f32 v106, v106
    v_exp_f32 v107, v107
    v_exp_f32 v108, v108
    v_exp_f32 v109, v109
    v_exp_f32 v110, v110
    v_exp_f32 v111, v111
    v_exp_f32 v80, v80
    v_exp_f32 v81, v81
    v_smfmac_f32_32x32x32_bf16 v[64:79], v[160:163], v[104:111], v12
    v_exp_f32 v82, v82
    v_exp_f32 v83, v83
    v_exp_f32 v84, v84
    v_mfma_f32_32x32x16_bf16 v[96:111], v[164:167], v[116:119], 4.0
    buffer_load_dwordx4 v[152:155], v13, s[40:43], s64 offen sc1
    v_exp_f32 v85, v85
    v_exp_f32 v86, v86
    v_exp_f32 v87, v87
    v_exp_f32 v88, v88
    v_exp_f32 v89, v89
    v_smfmac_f32_32x32x32_bf16 v[16:31], v[168:171], v[80:87], v12
    v_exp_f32 v90, v90
    v_exp_f32 v91, v91
    v_exp_f32 v92, v92
    v_exp_f32 v93, v93
    v_exp_f32 v94, v94
    v_exp_f32 v95, v95
    v_exp_f32 v96, v96
    v_exp_f32 v97, v97
    v_smfmac_f32_32x32x32_bf16 v[16:31], v[172:175], v[88:95], v12
    s_sub_u32 s66, s66, 1
    s_cmp_eq_u32 s66, 0
    v_exp_f32 v98, v98
    v_exp_f32 v99, v99
    v_exp_f32 v100, v100
    v_mfma_f32_32x32x16_bf16 v[80:95], v[164:167], v[120:123], 4.0
    v_exp_f32 v101, v101
    v_exp_f32 v102, v102
    v_exp_f32 v103, v103
    v_exp_f32 v104, v104
    v_exp_f32 v105, v105
    v_smfmac_f32_32x32x32_bf16 v[32:47], v[168:171], v[96:103], v12
    s_mov_b64 exec, s[52:53]
    buffer_load_dwordx4 v[156:159], v14, s[40:43], s64 offen offset:1024 sc1
    buffer_load_dwordx4 v[160:163], v14, s[40:43], s64 offen offset:1536 sc1
    s_mov_b64 exec, -1
    v_exp_f32 v106, v106
    v_exp_f32 v107, v107
    v_exp_f32 v108, v108
    v_exp_f32 v109, v109
    v_exp_f32 v110, v110
    v_exp_f32 v111, v111
    v_exp_f32 v80, v80
    v_exp_f32 v81, v81
    v_smfmac_f32_32x32x32_bf16 v[32:47], v[172:175], v[104:111], v12
    s_cbranch_scc1 L_attn_tail
    v_exp_f32 v82, v82
    v_exp_f32 v83, v83
    v_exp_f32 v84, v84
    v_mfma_f32_32x32x16_bf16 v[96:111], v[164:167], v[124:127], 4.0
    s_add_u32 s64, s64, 2048
    v_exp_f32 v85, v85
    v_exp_f32 v86, v86
    v_exp_f32 v87, v87
    v_exp_f32 v88, v88
    v_exp_f32 v89, v89
    v_smfmac_f32_32x32x32_bf16 v[48:63], v[168:171], v[80:87], v12
    v_exp_f32 v90, v90
    v_exp_f32 v91, v91
    v_exp_f32 v92, v92
    v_exp_f32 v93, v93
    v_exp_f32 v94, v94
    v_exp_f32 v95, v95
    v_exp_f32 v96, v96
    v_exp_f32 v97, v97
    v_smfmac_f32_32x32x32_bf16 v[48:63], v[172:175], v[88:95], v12
    s_waitcnt vmcnt(6)
    v_exp_f32 v98, v98
    v_exp_f32 v99, v99
    v_exp_f32 v100, v100
    v_mfma_f32_32x32x16_bf16 v[80:95], v[128:131], v[112:115], 4.0
    v_exp_f32 v101, v101
    v_exp_f32 v102, v102
    v_exp_f32 v103, v103
    v_exp_f32 v104, v104
    v_exp_f32 v105, v105
    v_smfmac_f32_32x32x32_bf16 v[64:79], v[168:171], v[96:103], v12
    v_exp_f32 v106, v106
    v_exp_f32 v107, v107
    v_exp_f32 v108, v108
    v_exp_f32 v109, v109
    v_exp_f32 v110, v110
    v_exp_f32 v111, v111
    v_exp_f32 v80, v80
    v_exp_f32 v81, v81
    v_smfmac_f32_32x32x32_bf16 v[64:79], v[172:175], v[104:111], v12
    s_branch L_attn
L_attn_tail:
    s_waitcnt lgkmcnt(0)
    ds_write_b128 v2, v[16:19] offset:0
    ds_write_b128 v2, v[20:23] offset:1024
    ds_write_b32 v3, v24 offset:2048
    v_exp_f32 v82, v82
    v_exp_f32 v83, v83
    v_exp_f32 v84, v84
    v_mfma_f32_32x32x16_bf16 v[96:111], v[164:167], v[124:127], 4.0
    s_lshl_b32 s55, s45, 1
    v_exp_f32 v85, v85
    v_exp_f32 v86, v86
    v_exp_f32 v87, v87
    v_exp_f32 v88, v88
    v_exp_f32 v89, v89
    v_smfmac_f32_32x32x32_bf16 v[48:63], v[168:171], v[80:87], v12
    ds_write_b128 v2, v[32:35] offset:2304
    ds_write_b128 v2, v[36:39] offset:3328
    ds_write_b32 v3, v40 offset:4352
    s_mov_b64 exec, 1
    ds_add_u32 v1, v7 offset:0
    s_mov_b64 exec, -1
    v_exp_f32 v90, v90
    v_exp_f32 v91, v91
    v_exp_f32 v92, v92
    v_exp_f32 v93, v93
    v_exp_f32 v94, v94
    v_exp_f32 v95, v95
    v_exp_f32 v96, v96
    v_exp_f32 v97, v97
    v_smfmac_f32_32x32x32_bf16 v[48:63], v[172:175], v[88:95], v12
    s_add_u32 s55, s55, s63
    s_lshl_b32 s54, s55, 5
    s_add_u32 s54, s54, s44
    s_lshl_b32 s54, s54, 1
    s_add_u32 s54, s54, s62
    s_mul_i32 s56, s63, -18432
    s_add_u32 s56, s56, 9216
    v_exp_f32 v98, v98
    v_exp_f32 v99, v99
    v_exp_f32 v100, v100
    v_exp_f32 v101, v101
    v_exp_f32 v102, v102
    v_exp_f32 v103, v103
    v_exp_f32 v104, v104
    v_exp_f32 v105, v105
    v_smfmac_f32_32x32x32_bf16 v[64:79], v[168:171], v[96:103], v12
    s_lshl_b32 s54, s54, 10
    s_add_u32 s54, s54, 4194304
    v_add_u32 v2, s56, v2
    v_add_u32 v3, s56, v3
    ds_read_b32 v4, v1 offset:0
    ds_read_b32 v200, v3 offset:2048
    ds_read_b128 v[192:195], v2 offset:0
    ds_read_b128 v[196:199], v2 offset:1024
    ds_read_b32 v212, v3 offset:4352
    ds_read_b128 v[204:207], v2 offset:2304
    ds_read_b128 v[208:211], v2 offset:3328
    v_exp_f32 v106, v106
    v_exp_f32 v107, v107
    v_exp_f32 v108, v108
    v_exp_f32 v109, v109
    v_exp_f32 v110, v110
    v_exp_f32 v111, v111
    s_lshl_b32 s55, s55, 3
    s_lshr_b32 s56, s44, 2
    v_smfmac_f32_32x32x32_bf16 v[64:79], v[172:175], v[104:111], v12
    s_add_u32 s55, s55, s56
    s_lshl_b32 s55, s55, 7
    s_add_u32 s55, s55, 12615680
    s_waitcnt lgkmcnt(0)
    v_cmp_gt_u32 vcc, 2, v4
    ds_write_b32 v15, v7
    s_cbranch_vccz L_have_9
    v_cmp_gt_u32 vcc, 2, v4
    s_cbranch_vccz L_ldone_11
    s_mov_b32 s70, 1000000
L_lspin_10:
    ds_read_b32 v4, v1 offset:0
    s_waitcnt lgkmcnt(0)
    v_cmp_gt_u32 vcc, 2, v4
    s_cbranch_vccz L_ldone_11
    s_sub_u32 s70, s70, 1
    s_cmp_lg_u32 s70, 0
    s_cbranch_scc1 L_lspin_10
L_ldone_11:
    ds_read_b32 v200, v3 offset:2048
    ds_read_b128 v[192:195], v2 offset:0
    ds_read_b128 v[196:199], v2 offset:1024
    ds_read_b32 v212, v3 offset:4352
    ds_read_b128 v[204:207], v2 offset:2304
    ds_read_b128 v[208:211], v2 offset:3328
    s_waitcnt lgkmcnt(3)
L_have_9:
    v_add_f32 v56, v56, v200
    v_add_f32 v48, v48, v192
    v_add_f32 v49, v49, v193
    v_add_f32 v50, v50, v194
    v_add_f32 v51, v51, v195
    v_add_f32 v52, v52, v196
    v_add_f32 v53, v53, v197
    v_add_f32 v54, v54, v198
    v_add_f32 v55, v55, v199
    v_rcp_f32 v57, v56
    s_add_u32 s58, s54, 0
    v_mul_f32 v48, v48, v57
    v_mul_f32 v49, v49, v57
    v_mul_f32 v50, v50, v57
    v_mul_f32 v51, v51, v57
    v_mul_f32 v52, v52, v57
    v_mul_f32 v53, v53, v57
    v_mul_f32 v54, v54, v57
    v_mul_f32 v55, v55, v57
    v_cvt_pk_bf16_f32 v224, v48, v49
    v_cvt_pk_bf16_f32 v225, v50, v51
    v_cvt_pk_bf16_f32 v226, v52, v53
    v_cvt_pk_bf16_f32 v227, v54, v55
    buffer_store_dwordx4 v[224:227], v13, s[40:43], s58 offen sc1
    s_waitcnt lgkmcnt(0)
    v_add_f32 v72, v72, v212
    v_add_f32 v64, v64, v204
    v_add_f32 v65, v65, v205
    v_add_f32 v66, v66, v206
    v_add_f32 v67, v67, v207
    v_add_f32 v68, v68, v208
    v_add_f32 v69, v69, v209
    v_add_f32 v70, v70, v210
    v_add_f32 v71, v71, v211
    v_rcp_f32 v73, v72
    s_add_u32 s58, s54, 32768
    v_mul_f32 v64, v64, v73
    v_mul_f32 v65, v65, v73
    v_mul_f32 v66, v66, v73
    v_mul_f32 v67, v67, v73
    v_mul_f32 v68, v68, v73
    v_mul_f32 v69, v69, v73
    v_mul_f32 v70, v70, v73
    v_mul_f32 v71, v71, v73
    v_cvt_pk_bf16_f32 v228, v64, v65
    v_cvt_pk_bf16_f32 v229, v66, v67
    v_cvt_pk_bf16_f32 v230, v68, v69
    v_cvt_pk_bf16_f32 v231, v70, v71
    buffer_store_dwordx4 v[228:231], v13, s[40:43], s58 offen sc1
    v_pk_add_f32 v[192:193], v[48:49], v[50:51]
    v_pk_add_f32 v[194:195], v[52:53], v[54:55]
    v_cmp_lt_f32 vcc, 0x33800000, v56
    v_pk_add_f32 v[192:193], v[192:193], v[194:195]
    s_and_b64 s[56:57], vcc, vcc
    v_cmp_gt_f32 vcc, 0x5f800000, v56
    v_add_f32 v192, v192, v193
    s_and_b64 s[56:57], s[56:57], vcc
    v_sub_f32 v192, v192, v192
    v_cmp_eq_f32 vcc, 0, v192
    s_and_b64 s[56:57], s[56:57], vcc
    v_pk_add_f32 v[204:205], v[64:65], v[66:67]
    v_pk_add_f32 v[206:207], v[68:69], v[70:71]
    v_cmp_lt_f32 vcc, 0x33800000, v72
    v_pk_add_f32 v[204:205], v[204:205], v[206:207]
    s_and_b64 s[56:57], s[56:57], vcc
    v_cmp_gt_f32 vcc, 0x5f800000, v72
    v_add_f32 v204, v204, v205
    s_and_b64 s[56:57], s[56:57], vcc
    v_sub_f32 v204, v204, v204
    v_cmp_eq_f32 vcc, 0, v204
    s_and_b64 s[56:57], s[56:57], vcc
    s_cmp_eq_u64 s[56:57], -1
    s_cbranch_scc0 L_fallback
L_publish:
    s_add_u32 s56, s55, 512
    s_waitcnt vmcnt(1)
    s_atomic_add s71, s[40:41], s55
    s_waitcnt vmcnt(0)
    s_atomic_add s71, s[40:41], s56
    s_endpgm
L_mwave:
    s_load_dwordx2 s[16:17], s[0:1], 32
    s_load_dwordx2 s[20:21], s[0:1], 40
    s_load_dwordx2 s[24:25], s[0:1], 48
    s_load_dwordx2 s[12:13], s[0:1], 16
    s_load_dwordx2 s[32:33], s[0:1], 64
    s_load_dwordx2 s[28:29], s[0:1], 56
    s_mov_b32 s38, 256
    s_mov_b32 s39, 0x00020000
    s_mov_b32 s18, 1409024
    s_mov_b32 s19, 0x00020000
    s_mov_b32 s22, 1409024
    s_mov_b32 s23, 0x00020000
    s_mov_b32 s26, 1409024
    s_mov_b32 s27, 0x00020000
    s_mov_b32 s14, 524288
    s_mov_b32 s15, 0x00020000
    s_mov_b32 s34, 2097152
    s_mov_b32 s35, 0x00020000
    s_mov_b32 s30, 1024
    s_mov_b32 s31, 0x00020000
    s_lshl_b32 s49, s54, 2
    s_and_b32 s56, s55, 3
    s_add_u32 s49, s49, s56
    s_lshr_b32 s50, s55, 2
    v_and_b32 v16, 31, v0
    v_lshrrev_b32 v17, 5, v0
    v_bfe_u32 v18, v0, 1, 3
    v_xor_b32 v18, v18, v17
    s_lshl_b32 s54, s47, 12
    v_lshlrev_b32 v19, 7, v16
    v_lshl_add_u32 v19, v18, 4, v19
    v_add_u32 v80, s54, v19
    v_xor_b32 v81, 32, v80
    v_xor_b32 v82, 64, v80
    v_xor_b32 v83, 96, v80
    v_add_u32 v84, 0x10000, v80
    v_add_u32 v85, 0x10000, v81
    v_add_u32 v86, 0x10000, v82
    v_add_u32 v87, 0x10000, v83
    v_bfe_u32 v18, v0, 2, 2
    v_lshl_add_u32 v18, v17, 3, v18
    v_bfe_u32 v19, v0, 4, 1
    v_and_b32 v20, 3, v0
    v_lshlrev_b32 v20, 3, v20
    v_lshl_add_u32 v20, v19, 5, v20
    v_bfe_u32 v21, v0, 3, 1
    v_lshl_add_u32 v22, v18, 7, v20
    v_lshl_add_u32 v88, v21, 6, v22
    v_xor_b32 v89, 64, v88
    v_add_u32 v90, 0x10000, v88
    v_add_u32 v91, 0x10000, v89
    v_lshl_add_u32 v92, v18, 6, v20
    v_add_u32 v92, 98304, v92
    s_lshl_b32 s54, s47, 10
    s_add_u32 s54, s54, 131072
    v_lshl_add_u32 v95, v0, 4, s54
    v_and_b32 v23, 0x33, v0
    v_bfe_u32 v25, v0, 2, 1
    v_lshl_add_u32 v23, v25, 3, v23
    v_lshl_add_u32 v23, v21, 2, v23
    v_lshlrev_b32 v23, 4, v23
    v_and_b32 v24, 15, v0
    v_lshlrev_b32 v96, 7, v17
    v_lshlrev_b32 v24, 4, v24
    v_lshl_add_u32 v24, v17, 8, v24
    v_lshl_add_u32 v24, v19, 17, v24
    v_add_u32 v24, 1024, v24
    v_lshlrev_b32 v26, 4, v0
    s_lshl_b32 s54, s47, 4
    v_bfe_u32 v27, v0, 2, 3
    v_add_u32 v27, s54, v27
    v_mul_u32_u24 v27, 2752, v27
    v_and_b32 v28, 3, v0
    v_lshl_add_u32 v27, v28, 4, v27
    v_lshl_add_u32 v2, v17, 6, v27
    s_lshr_b32 s54, s48, 2
    v_xor_b32 v28, s54, v17
    v_mul_u32_u24 v28, 704512, v28
    v_add_u32 v3, v27, v28
    v_and_b32 v27, 0x300, v26
    v_add_u32 v4, v27, v26
    v_mul_u32_u24 v20, 2064, v19
    v_lshl_add_u32 v20, v17, 10, v20
    v_bfe_u32 v27, v0, 1, 3
    v_lshl_add_u32 v20, v27, 5, v20
    v_and_b32 v27, 1, v0
    v_lshl_add_u32 v0, v27, 3, v20
    v_bfe_u32 v20, v26, 4, 3
    v_lshlrev_b32 v22, 2, v19
    v_xor_b32 v20, v20, v22
    v_lshlrev_b32 v20, 4, v20
    v_lshrrev_b32 v22, 7, v26
    v_lshl_add_u32 v1, v22, 10, v20
    v_mov_b32 v5, 158208
    v_lshl_add_u32 v6, v26, 3, 4
    v_mov_b32 v100, 0
    v_mov_b32 v101, 0
    v_mov_b32 v102, 0
    v_mov_b32 v103, 0
    ds_write_b128 v5, v[100:103]
    ds_write_b128 v5, v[100:103] offset:16
    ds_write_b128 v5, v[100:103] offset:32
    ds_write_b128 v5, v[100:103] offset:48
    s_waitcnt lgkmcnt(0)
    s_bitcmp1_b32 s44, 0
    s_cbranch_scc1 L_pass_v
    v_mov_b32 v93, v23
    s_lshr_b32 s56, s44, 1
    s_lshl_b32 s56, s56, 19
    s_lshl_b32 s57, s45, 2
    s_add_u32 s57, s57, s47
    s_lshl_b32 s57, s57, 11
    s_add_u32 s56, s56, s57
    s_barrier
    ds_read_b128 v[128:131], v80 offset:0
    ds_read_b64_tr_b16 v[8:9], v88 offset:16384
    ds_read_b64_tr_b16 v[10:11], v88 offset:16896
    ds_read_b64_tr_b16 v[12:13], v89 offset:16384
    ds_read_b64_tr_b16 v[14:15], v89 offset:16896
    ds_read_b128 v[132:135], v81 offset:0
    ds_read_b64_tr_b16 v[16:17], v88 offset:18432
    ds_read_b64_tr_b16 v[18:19], v88 offset:18944
    ds_read_b64_tr_b16 v[20:21], v89 offset:18432
    ds_read_b64_tr_b16 v[22:23], v89 offset:18944
    ds_read_b128 v[136:139], v82 offset:0
    ds_read_b64_tr_b16 v[24:25], v88 offset:20480
    ds_read_b64_tr_b16 v[26:27], v88 offset:20992
    ds_read_b64_tr_b16 v[28:29], v89 offset:20480
    ds_read_b64_tr_b16 v[30:31], v89 offset:20992
    s_waitcnt lgkmcnt(12)
    v_mfma_f32_32x32x16_bf16 v[32:47], v[8:11], v[128:131], 0
    s_waitcnt lgkmcnt(10)
    v_mfma_f32_32x32x16_bf16 v[48:63], v[12:15], v[128:131], 0
    ds_read_b128 v[140:143], v83 offset:0
    ds_read_b64_tr_b16 v[8:9], v88 offset:22528
    ds_read_b64_tr_b16 v[10:11], v88 offset:23040
    ds_read_b64_tr_b16 v[12:13], v89 offset:22528
    ds_read_b64_tr_b16 v[14:15], v89 offset:23040
    s_waitcnt lgkmcnt(12)
    v_mfma_f32_32x32x16_bf16 v[32:47], v[16:19], v[132:135], v[32:47]
    s_waitcnt lgkmcnt(10)
    v_mfma_f32_32x32x16_bf16 v[48:63], v[20:23], v[132:135], v[48:63]
    s_waitcnt lgkmcnt(7)
    v_mfma_f32_32x32x16_bf16 v[32:47], v[24:27], v[136:139], v[32:47]
    s_waitcnt lgkmcnt(5)
    v_mfma_f32_32x32x16_bf16 v[48:63], v[28:31], v[136:139], v[48:63]
    s_waitcnt lgkmcnt(0)
    s_barrier
    ds_read_b128 v[144:147], v80 offset:24576
    ds_read_b64_tr_b16 v[16:17], v88 offset:40960
    ds_read_b64_tr_b16 v[18:19], v88 offset:41472
    ds_read_b64_tr_b16 v[20:21], v89 offset:40960
    ds_read_b64_tr_b16 v[22:23], v89 offset:41472
    ds_read_b128 v[148:151], v81 offset:24576
    ds_read_b64_tr_b16 v[24:25], v88 offset:43008
    ds_read_b64_tr_b16 v[26:27], v88 offset:43520
    ds_read_b64_tr_b16 v[28:29], v89 offset:43008
    ds_read_b64_tr_b16 v[30:31], v89 offset:43520
    v_mfma_f32_32x32x16_bf16 v[32:47], v[8:11], v[140:143], v[32:47]
    v_mfma_f32_32x32x16_bf16 v[48:63], v[12:15], v[140:143], v[48:63]
    ds_read_b128 v[152:155], v82 offset:24576
    ds_read_b64_tr_b16 v[8:9], v88 offset:45056
    ds_read_b64_tr_b16 v[10:11], v88 offset:45568
    ds_read_b64_tr_b16 v[12:13], v89 offset:45056
    ds_read_b64_tr_b16 v[14:15], v89 offset:45568
    s_waitcnt lgkmcnt(12)
    v_mfma_f32_32x32x16_bf16 v[32:47], v[16:19], v[144:147], v[32:47]
    s_waitcnt lgkmcnt(10)
    v_mfma_f32_32x32x16_bf16 v[48:63], v[20:23], v[144:147], v[48:63]
    ds_read_b128 v[156:159], v83 offset:24576
    ds_read_b64_tr_b16 v[16:17], v88 offset:47104
    ds_read_b64_tr_b16 v[18:19], v88 offset:47616
    ds_read_b64_tr_b16 v[20:21], v89 offset:47104
    ds_read_b64_tr_b16 v[22:23], v89 offset:47616
    s_waitcnt lgkmcnt(12)
    v_mfma_f32_32x32x16_bf16 v[32:47], v[24:27], v[148:151], v[32:47]
    s_waitcnt lgkmcnt(10)
    v_mfma_f32_32x32x16_bf16 v[48:63], v[28:31], v[148:151], v[48:63]
    s_waitcnt lgkmcnt(7)
    v_mfma_f32_32x32x16_bf16 v[32:47], v[8:11], v[152:155], v[32:47]
    s_waitcnt lgkmcnt(5)
    v_mfma_f32_32x32x16_bf16 v[48:63], v[12:15], v[152:155], v[48:63]
    s_waitcnt lgkmcnt(0)
    s_barrier
    ds_read_b128 v[160:163], v80 offset:49152
    ds_read_b64_tr_b16 v[24:25], v90 offset:0
    ds_read_b64_tr_b16 v[26:27], v90 offset:512
    ds_read_b64_tr_b16 v[28:29], v91 offset:0
    ds_read_b64_tr_b16 v[30:31], v91 offset:512
    ds_read_b128 v[164:167], v81 offset:49152
    ds_read_b64_tr_b16 v[8:9], v90 offset:2048
    ds_read_b64_tr_b16 v[10:11], v90 offset:2560
    ds_read_b64_tr_b16 v[12:13], v91 offset:2048
    ds_read_b64_tr_b16 v[14:15], v91 offset:2560
    v_mfma_f32_32x32x16_bf16 v[32:47], v[16:19], v[156:159], v[32:47]
    v_mfma_f32_32x32x16_bf16 v[48:63], v[20:23], v[156:159], v[48:63]
    ds_read_b128 v[168:171], v82 offset:49152
    ds_read_b64_tr_b16 v[16:17], v90 offset:4096
    ds_read_b64_tr_b16 v[18:19], v90 offset:4608
    ds_read_b64_tr_b16 v[20:21], v91 offset:4096
    ds_read_b64_tr_b16 v[22:23], v91 offset:4608
    s_waitcnt lgkmcnt(12)
    v_mfma_f32_32x32x16_bf16 v[32:47], v[24:27], v[160:163], v[32:47]
    s_waitcnt lgkmcnt(10)
    v_mfma_f32_32x32x16_bf16 v[48:63], v[28:31], v[160:163], v[48:63]
    ds_read_b128 v[172:175], v83 offset:49152
    ds_read_b64_tr_b16 v[24:25], v90 offset:6144
    ds_read_b64_tr_b16 v[26:27], v90 offset:6656
    ds_read_b64_tr_b16 v[28:29], v91 offset:6144
    ds_read_b64_tr_b16 v[30:31], v91 offset:6656
    s_waitcnt lgkmcnt(12)
    v_mfma_f32_32x32x16_bf16 v[32:47], v[8:11], v[164:167], v[32:47]
    s_waitcnt lgkmcnt(10)
    v_mfma_f32_32x32x16_bf16 v[48:63], v[12:15], v[164:167], v[48:63]
    s_waitcnt lgkmcnt(7)
    v_mfma_f32_32x32x16_bf16 v[32:47], v[16:19], v[168:171], v[32:47]
    s_waitcnt lgkmcnt(5)
    v_mfma_f32_32x32x16_bf16 v[48:63], v[20:23], v[168:171], v[48:63]
    s_waitcnt lgkmcnt(0)
    s_barrier
    ds_read_b128 v[176:179], v84 offset:8192
    ds_read_b64_tr_b16 v[8:9], v90 offset:24576
    ds_read_b64_tr_b16 v[10:11], v90 offset:25088
    ds_read_b64_tr_b16 v[12:13], v91 offset:24576
    ds_read_b64_tr_b16 v[14:15], v91 offset:25088
    ds_read_b128 v[180:183], v85 offset:8192
    ds_read_b64_tr_b16 v[16:17], v90 offset:26624
    ds_read_b64_tr_b16 v[18:19], v90 offset:27136
    ds_read_b64_tr_b16 v[20:21], v91 offset:26624
    ds_read_b64_tr_b16 v[22:23], v91 offset:27136
    v_mfma_f32_32x32x16_bf16 v[32:47], v[24:27], v[172:175], v[32:47]
    v_mfma_f32_32x32x16_bf16 v[48:63], v[28:31], v[172:175], v[48:63]
    ds_read_b128 v[184:187], v86 offset:8192
    ds_read_b64_tr_b16 v[24:25], v90 offset:28672
    ds_read_b64_tr_b16 v[26:27], v90 offset:29184
    ds_read_b64_tr_b16 v[28:29], v91 offset:28672
    ds_read_b64_tr_b16 v[30:31], v91 offset:29184
    s_waitcnt lgkmcnt(12)
    v_mfma_f32_32x32x16_bf16 v[32:47], v[8:11], v[176:179], v[32:47]
    s_waitcnt lgkmcnt(10)
    v_mfma_f32_32x32x16_bf16 v[48:63], v[12:15], v[176:179], v[48:63]
    ds_read_b128 v[188:191], v87 offset:8192
    ds_read_b64_tr_b16 v[8:9], v90 offset:30720
    ds_read_b64_tr_b16 v[10:11], v90 offset:31232
    ds_read_b64_tr_b16 v[12:13], v91 offset:30720
    ds_read_b64_tr_b16 v[14:15], v91 offset:31232
    s_waitcnt lgkmcnt(12)
    v_mfma_f32_32x32x16_bf16 v[32:47], v[16:19], v[180:183], v[32:47]
    s_waitcnt lgkmcnt(10)
    v_mfma_f32_32x32x16_bf16 v[48:63], v[20:23], v[180:183], v[48:63]
    s_waitcnt lgkmcnt(7)
    v_mfma_f32_32x32x16_bf16 v[32:47], v[24:27], v[184:187], v[32:47]
    s_waitcnt lgkmcnt(5)
    v_mfma_f32_32x32x16_bf16 v[48:63], v[28:31], v[184:187], v[48:63]
    s_waitcnt lgkmcnt(0)
    s_barrier
    ds_read_b128 v[192:195], v80 offset:0
    ds_read_b64_tr_b16 v[16:17], v88 offset:16384
    ds_read_b64_tr_b16 v[18:19], v88 offset:16896
    ds_read_b64_tr_b16 v[20:21], v89 offset:16384
    ds_read_b64_tr_b16 v[22:23], v89 offset:16896
    ds_read_b128 v[196:199], v81 offset:0
    ds_read_b64_tr_b16 v[24:25], v88 offset:18432
    ds_read_b64_tr_b16 v[26:27], v88 offset:18944
    ds_read_b64_tr_b16 v[28:29], v89 offset:18432
    ds_read_b64_tr_b16 v[30:31], v89 offset:18944
    v_mfma_f32_32x32x16_bf16 v[32:47], v[8:11], v[188:191], v[32:47]
    v_mfma_f32_32x32x16_bf16 v[48:63], v[12:15], v[188:191], v[48:63]
    ds_read_b128 v[200:203], v82 offset:0
    ds_read_b64_tr_b16 v[8:9], v88 offset:20480
    ds_read_b64_tr_b16 v[10:11], v88 offset:20992
    ds_read_b64_tr_b16 v[12:13], v89 offset:20480
    ds_read_b64_tr_b16 v[14:15], v89 offset:20992
    s_waitcnt lgkmcnt(12)
    v_mfma_f32_32x32x16_bf16 v[32:47], v[16:19], v[192:195], v[32:47]
    s_waitcnt lgkmcnt(10)
    v_mfma_f32_32x32x16_bf16 v[48:63], v[20:23], v[192:195], v[48:63]
    ds_read_b128 v[204:207], v83 offset:0
    ds_read_b64_tr_b16 v[16:17], v88 offset:22528
    ds_read_b64_tr_b16 v[18:19], v88 offset:23040
    ds_read_b64_tr_b16 v[20:21], v89 offset:22528
    ds_read_b64_tr_b16 v[22:23], v89 offset:23040
    s_waitcnt lgkmcnt(12)
    v_mfma_f32_32x32x16_bf16 v[32:47], v[24:27], v[196:199], v[32:47]
    s_waitcnt lgkmcnt(10)
    v_mfma_f32_32x32x16_bf16 v[48:63], v[28:31], v[196:199], v[48:63]
    s_waitcnt lgkmcnt(7)
    v_mfma_f32_32x32x16_bf16 v[32:47], v[8:11], v[200:203], v[32:47]
    s_waitcnt lgkmcnt(5)
    v_mfma_f32_32x32x16_bf16 v[48:63], v[12:15], v[200:203], v[48:63]
    s_waitcnt lgkmcnt(0)
    s_barrier
    ds_read_b128 v[208:211], v80 offset:24576
    ds_read_b64_tr_b16 v[24:25], v88 offset:40960
    ds_read_b64_tr_b16 v[26:27], v88 offset:41472
    ds_read_b64_tr_b16 v[28:29], v89 offset:40960
    ds_read_b64_tr_b16 v[30:31], v89 offset:41472
    ds_read_b128 v[212:215], v81 offset:24576
    ds_read_b64_tr_b16 v[8:9], v88 offset:43008
    ds_read_b64_tr_b16 v[10:11], v88 offset:43520
    ds_read_b64_tr_b16 v[12:13], v89 offset:43008
    ds_read_b64_tr_b16 v[14:15], v89 offset:43520
    v_mfma_f32_32x32x16_bf16 v[32:47], v[16:19], v[204:207], v[32:47]
    v_mfma_f32_32x32x16_bf16 v[48:63], v[20:23], v[204:207], v[48:63]
    ds_read_b128 v[216:219], v82 offset:24576
    ds_read_b64_tr_b16 v[16:17], v88 offset:45056
    ds_read_b64_tr_b16 v[18:19], v88 offset:45568
    ds_read_b64_tr_b16 v[20:21], v89 offset:45056
    ds_read_b64_tr_b16 v[22:23], v89 offset:45568
    s_waitcnt lgkmcnt(12)
    v_mfma_f32_32x32x16_bf16 v[32:47], v[24:27], v[208:211], v[32:47]
    s_waitcnt lgkmcnt(10)
    v_mfma_f32_32x32x16_bf16 v[48:63], v[28:31], v[208:211], v[48:63]
    ds_read_b128 v[220:223], v83 offset:24576
    ds_read_b64_tr_b16 v[24:25], v88 offset:47104
    ds_read_b64_tr_b16 v[26:27], v88 offset:47616
    ds_read_b64_tr_b16 v[28:29], v89 offset:47104
    ds_read_b64_tr_b16 v[30:31], v89 offset:47616
    s_waitcnt lgkmcnt(12)
    v_mfma_f32_32x32x16_bf16 v[32:47], v[8:11], v[212:215], v[32:47]
    s_waitcnt lgkmcnt(10)
    v_mfma_f32_32x32x16_bf16 v[48:63], v[12:15], v[212:215], v[48:63]
    s_waitcnt lgkmcnt(7)
    v_mfma_f32_32x32x16_bf16 v[32:47], v[16:19], v[216:219], v[32:47]
    s_waitcnt lgkmcnt(5)
    v_mfma_f32_32x32x16_bf16 v[48:63], v[20:23], v[216:219], v[48:63]
    s_waitcnt lgkmcnt(0)
    s_barrier
    ds_read_b128 v[224:227], v80 offset:49152
    ds_read_b64_tr_b16 v[8:9], v90 offset:0
    ds_read_b64_tr_b16 v[10:11], v90 offset:512
    ds_read_b64_tr_b16 v[12:13], v91 offset:0
    ds_read_b64_tr_b16 v[14:15], v91 offset:512
    ds_read_b128 v[228:231], v81 offset:49152
    ds_read_b64_tr_b16 v[16:17], v90 offset:2048
    ds_read_b64_tr_b16 v[18:19], v90 offset:2560
    ds_read_b64_tr_b16 v[20:21], v91 offset:2048
    ds_read_b64_tr_b16 v[22:23], v91 offset:2560
    v_mfma_f32_32x32x16_bf16 v[32:47], v[24:27], v[220:223], v[32:47]
    v_mfma_f32_32x32x16_bf16 v[48:63], v[28:31], v[220:223], v[48:63]
    ds_read_b128 v[232:235], v82 offset:49152
    ds_read_b64_tr_b16 v[24:25], v90 offset:4096
    ds_read_b64_tr_b16 v[26:27], v90 offset:4608
    ds_read_b64_tr_b16 v[28:29], v91 offset:4096
    ds_read_b64_tr_b16 v[30:31], v91 offset:4608
    buffer_load_dword v94, v96, s[36:39], 0 offen sc1
    s_waitcnt lgkmcnt(12)
    v_mfma_f32_32x32x16_bf16 v[32:47], v[8:11], v[224:227], v[32:47]
    s_waitcnt lgkmcnt(10)
    v_mfma_f32_32x32x16_bf16 v[48:63], v[12:15], v[224:227], v[48:63]
    ds_read_b128 v[236:239], v83 offset:49152
    ds_read_b64_tr_b16 v[8:9], v90 offset:6144
    ds_read_b64_tr_b16 v[10:11], v90 offset:6656
    ds_read_b64_tr_b16 v[12:13], v91 offset:6144
    ds_read_b64_tr_b16 v[14:15], v91 offset:6656
    s_waitcnt lgkmcnt(12)
    v_mfma_f32_32x32x16_bf16 v[32:47], v[16:19], v[228:231], v[32:47]
    s_waitcnt lgkmcnt(10)
    v_mfma_f32_32x32x16_bf16 v[48:63], v[20:23], v[228:231], v[48:63]
    s_waitcnt lgkmcnt(7)
    v_mfma_f32_32x32x16_bf16 v[32:47], v[24:27], v[232:235], v[32:47]
    s_waitcnt lgkmcnt(5)
    v_mfma_f32_32x32x16_bf16 v[48:63], v[28:31], v[232:235], v[48:63]
    s_waitcnt lgkmcnt(0)
    v_mfma_f32_32x32x16_bf16 v[32:47], v[8:11], v[236:239], v[32:47]
    v_mfma_f32_32x32x16_bf16 v[48:63], v[12:15], v[236:239], v[48:63]
    s_barrier
    ds_read_b128 v[240:243], v84 offset:8192
    ds_read_b64_tr_b16 v[16:17], v90 offset:24576
    ds_read_b64_tr_b16 v[18:19], v90 offset:25088
    ds_read_b64_tr_b16 v[20:21], v91 offset:24576
    ds_read_b64_tr_b16 v[22:23], v91 offset:25088
    ds_read_b128 v[244:247], v85 offset:8192
    ds_read_b64_tr_b16 v[24:25], v90 offset:26624
    ds_read_b64_tr_b16 v[26:27], v90 offset:27136
    ds_read_b64_tr_b16 v[28:29], v91 offset:26624
    ds_read_b64_tr_b16 v[30:31], v91 offset:27136
    ds_read_b128 v[248:251], v86 offset:8192
    ds_read_b64_tr_b16 v[8:9], v90 offset:28672
    ds_read_b64_tr_b16 v[10:11], v90 offset:29184
    ds_read_b64_tr_b16 v[12:13], v91 offset:28672
    ds_read_b64_tr_b16 v[14:15], v91 offset:29184
    s_waitcnt lgkmcnt(12)
    v_mfma_f32_32x32x16_bf16 v[32:47], v[16:19], v[240:243], v[32:47]
    ds_read_b128 v[252:255], v87 offset:8192
    ds_read_b64_tr_b16 v[104:105], v90 offset:30720
    ds_read_b64_tr_b16 v[106:107], v90 offset:31232
    ds_read_b64_tr_b16 v[108:109], v91 offset:30720
    ds_read_b64_tr_b16 v[110:111], v91 offset:31232
    s_waitcnt lgkmcnt(12)
    v_mfma_f32_32x32x16_bf16 v[32:47], v[24:27], v[244:247], v[32:47]
    s_waitcnt lgkmcnt(7)
    v_mfma_f32_32x32x16_bf16 v[32:47], v[8:11], v[248:251], v[32:47]
    s_waitcnt lgkmcnt(2)
    v_mfma_f32_32x32x16_bf16 v[32:47], v[104:107], v[252:255], v[32:47]
    v_mfma_f32_32x32x16_bf16 v[48:63], v[20:23], v[240:243], v[48:63]
    s_nop 5
    v_mfma_f32_32x32x16_bf16 v[48:63], v[28:31], v[244:247], v[48:63]
    s_nop 3
    v_cvt_pk_bf16_f32 v112, v32, v33
    v_cvt_pk_bf16_f32 v113, v34, v35
    v_cvt_pk_bf16_f32 v114, v36, v37
    v_cvt_pk_bf16_f32 v115, v38, v39
    buffer_store_dwordx4 v[112:115], v93, s[40:43], s56 offen sc1
    s_add_u32 s56, s56, 131072
    v_mfma_f32_32x32x16_bf16 v[48:63], v[12:15], v[248:251], v[48:63]
    s_waitcnt lgkmcnt(0)
    v_mfma_f32_32x32x16_bf16 v[48:63], v[108:111], v[252:255], v[48:63]
    v_cvt_pk_bf16_f32 v116, v40, v41
    v_cvt_pk_bf16_f32 v117, v42, v43
    v_cvt_pk_bf16_f32 v118, v44, v45
    v_cvt_pk_bf16_f32 v119, v46, v47
    buffer_store_dwordx4 v[116:119], v93, s[40:43], s56 offen sc1
    s_add_u32 s56, s56, 131072
    s_nop 5
    v_cvt_pk_bf16_f32 v120, v48, v49
    v_cvt_pk_bf16_f32 v121, v50, v51
    v_cvt_pk_bf16_f32 v122, v52, v53
    v_cvt_pk_bf16_f32 v123, v54, v55
    buffer_store_dwordx4 v[120:123], v93, s[40:43], s56 offen sc1
    s_add_u32 s56, s56, 131072
    v_cvt_pk_bf16_f32 v124, v56, v57
    v_cvt_pk_bf16_f32 v125, v58, v59
    v_cvt_pk_bf16_f32 v126, v60, v61
    v_cvt_pk_bf16_f32 v127, v62, v63
    buffer_store_dwordx4 v[124:127], v93, s[40:43], s56 offen sc1
    s_add_u32 s56, s56, 131072
    s_branch L_pass_q
L_pass_v:
    v_mov_b32 v93, v24
    s_lshr_b32 s56, s44, 1
    s_lshl_b32 s56, s56, 19
    s_lshl_b32 s57, s45, 2
    s_add_u32 s57, s57, s47
    s_lshl_b32 s57, s57, 11
    s_add_u32 s56, s56, s57
    s_barrier
    ds_read_b128 v[128:131], v80 offset:0
    ds_read_b64_tr_b16 v[8:9], v88 offset:16384
    ds_read_b64_tr_b16 v[10:11], v88 offset:16896
    ds_read_b64_tr_b16 v[12:13], v89 offset:16384
    ds_read_b64_tr_b16 v[14:15], v89 offset:16896
    ds_read_b128 v[132:135], v81 offset:0
    ds_read_b64_tr_b16 v[16:17], v88 offset:18432
    ds_read_b64_tr_b16 v[18:19], v88 offset:18944
    ds_read_b64_tr_b16 v[20:21], v89 offset:18432
    ds_read_b64_tr_b16 v[22:23], v89 offset:18944
    ds_read_b128 v[136:139], v82 offset:0
    ds_read_b64_tr_b16 v[24:25], v88 offset:20480
    ds_read_b64_tr_b16 v[26:27], v88 offset:20992
    ds_read_b64_tr_b16 v[28:29], v89 offset:20480
    ds_read_b64_tr_b16 v[30:31], v89 offset:20992
    s_waitcnt lgkmcnt(12)
    v_mfma_f32_32x32x16_bf16 v[32:47], v[128:131], v[8:11], 0
    s_waitcnt lgkmcnt(10)
    v_mfma_f32_32x32x16_bf16 v[48:63], v[128:131], v[12:15], 0
    ds_read_b128 v[140:143], v83 offset:0
    ds_read_b64_tr_b16 v[8:9], v88 offset:22528
    ds_read_b64_tr_b16 v[10:11], v88 offset:23040
    ds_read_b64_tr_b16 v[12:13], v89 offset:22528
    ds_read_b64_tr_b16 v[14:15], v89 offset:23040
    s_waitcnt lgkmcnt(12)
    v_mfma_f32_32x32x16_bf16 v[32:47], v[132:135], v[16:19], v[32:47]
    s_waitcnt lgkmcnt(10)
    v_mfma_f32_32x32x16_bf16 v[48:63], v[132:135], v[20:23], v[48:63]
    s_waitcnt lgkmcnt(7)
    v_mfma_f32_32x32x16_bf16 v[32:47], v[136:139], v[24:27], v[32:47]
    s_waitcnt lgkmcnt(5)
    v_mfma_f32_32x32x16_bf16 v[48:63], v[136:139], v[28:31], v[48:63]
    s_waitcnt lgkmcnt(0)
    s_barrier
    ds_read_b128 v[144:147], v80 offset:24576
    ds_read_b64_tr_b16 v[16:17], v88 offset:40960
    ds_read_b64_tr_b16 v[18:19], v88 offset:41472
    ds_read_b64_tr_b16 v[20:21], v89 offset:40960
    ds_read_b64_tr_b16 v[22:23], v89 offset:41472
    ds_read_b128 v[148:151], v81 offset:24576
    ds_read_b64_tr_b16 v[24:25], v88 offset:43008
    ds_read_b64_tr_b16 v[26:27], v88 offset:43520
    ds_read_b64_tr_b16 v[28:29], v89 offset:43008
    ds_read_b64_tr_b16 v[30:31], v89 offset:43520
    v_mfma_f32_32x32x16_bf16 v[32:47], v[140:143], v[8:11], v[32:47]
    v_mfma_f32_32x32x16_bf16 v[48:63], v[140:143], v[12:15], v[48:63]
    ds_read_b128 v[152:155], v82 offset:24576
    ds_read_b64_tr_b16 v[8:9], v88 offset:45056
    ds_read_b64_tr_b16 v[10:11], v88 offset:45568
    ds_read_b64_tr_b16 v[12:13], v89 offset:45056
    ds_read_b64_tr_b16 v[14:15], v89 offset:45568
    s_waitcnt lgkmcnt(12)
    v_mfma_f32_32x32x16_bf16 v[32:47], v[144:147], v[16:19], v[32:47]
    s_waitcnt lgkmcnt(10)
    v_mfma_f32_32x32x16_bf16 v[48:63], v[144:147], v[20:23], v[48:63]
    ds_read_b128 v[156:159], v83 offset:24576
    ds_read_b64_tr_b16 v[16:17], v88 offset:47104
    ds_read_b64_tr_b16 v[18:19], v88 offset:47616
    ds_read_b64_tr_b16 v[20:21], v89 offset:47104
    ds_read_b64_tr_b16 v[22:23], v89 offset:47616
    s_waitcnt lgkmcnt(12)
    v_mfma_f32_32x32x16_bf16 v[32:47], v[148:151], v[24:27], v[32:47]
    s_waitcnt lgkmcnt(10)
    v_mfma_f32_32x32x16_bf16 v[48:63], v[148:151], v[28:31], v[48:63]
    s_waitcnt lgkmcnt(7)
    v_mfma_f32_32x32x16_bf16 v[32:47], v[152:155], v[8:11], v[32:47]
    s_waitcnt lgkmcnt(5)
    v_mfma_f32_32x32x16_bf16 v[48:63], v[152:155], v[12:15], v[48:63]
    s_waitcnt lgkmcnt(0)
    s_barrier
    ds_read_b128 v[160:163], v80 offset:49152
    ds_read_b64_tr_b16 v[24:25], v90 offset:0
    ds_read_b64_tr_b16 v[26:27], v90 offset:512
    ds_read_b64_tr_b16 v[28:29], v91 offset:0
    ds_read_b64_tr_b16 v[30:31], v91 offset:512
    ds_read_b128 v[164:167], v81 offset:49152
    ds_read_b64_tr_b16 v[8:9], v90 offset:2048
    ds_read_b64_tr_b16 v[10:11], v90 offset:2560
    ds_read_b64_tr_b16 v[12:13], v91 offset:2048
    ds_read_b64_tr_b16 v[14:15], v91 offset:2560
    v_mfma_f32_32x32x16_bf16 v[32:47], v[156:159], v[16:19], v[32:47]
    v_mfma_f32_32x32x16_bf16 v[48:63], v[156:159], v[20:23], v[48:63]
    ds_read_b128 v[168:171], v82 offset:49152
    ds_read_b64_tr_b16 v[16:17], v90 offset:4096
    ds_read_b64_tr_b16 v[18:19], v90 offset:4608
    ds_read_b64_tr_b16 v[20:21], v91 offset:4096
    ds_read_b64_tr_b16 v[22:23], v91 offset:4608
    s_waitcnt lgkmcnt(12)
    v_mfma_f32_32x32x16_bf16 v[32:47], v[160:163], v[24:27], v[32:47]
    s_waitcnt lgkmcnt(10)
    v_mfma_f32_32x32x16_bf16 v[48:63], v[160:163], v[28:31], v[48:63]
    ds_read_b128 v[172:175], v83 offset:49152
    ds_read_b64_tr_b16 v[24:25], v90 offset:6144
    ds_read_b64_tr_b16 v[26:27], v90 offset:6656
    ds_read_b64_tr_b16 v[28:29], v91 offset:6144
    ds_read_b64_tr_b16 v[30:31], v91 offset:6656
    s_waitcnt lgkmcnt(12)
    v_mfma_f32_32x32x16_bf16 v[32:47], v[164:167], v[8:11], v[32:47]
    s_waitcnt lgkmcnt(10)
    v_mfma_f32_32x32x16_bf16 v[48:63], v[164:167], v[12:15], v[48:63]
    s_waitcnt lgkmcnt(7)
    v_mfma_f32_32x32x16_bf16 v[32:47], v[168:171], v[16:19], v[32:47]
    s_waitcnt lgkmcnt(5)
    v_mfma_f32_32x32x16_bf16 v[48:63], v[168:171], v[20:23], v[48:63]
    s_waitcnt lgkmcnt(0)
    s_barrier
    ds_read_b128 v[176:179], v84 offset:8192
    ds_read_b64_tr_b16 v[8:9], v90 offset:24576
    ds_read_b64_tr_b16 v[10:11], v90 offset:25088
    ds_read_b64_tr_b16 v[12:13], v91 offset:24576
    ds_read_b64_tr_b16 v[14:15], v91 offset:25088
    ds_read_b128 v[180:183], v85 offset:8192
    ds_read_b64_tr_b16 v[16:17], v90 offset:26624
    ds_read_b64_tr_b16 v[18:19], v90 offset:27136
    ds_read_b64_tr_b16 v[20:21], v91 offset:26624
    ds_read_b64_tr_b16 v[22:23], v91 offset:27136
    v_mfma_f32_32x32x16_bf16 v[32:47], v[172:175], v[24:27], v[32:47]
    v_mfma_f32_32x32x16_bf16 v[48:63], v[172:175], v[28:31], v[48:63]
    ds_read_b128 v[184:187], v86 offset:8192
    ds_read_b64_tr_b16 v[24:25], v90 offset:28672
    ds_read_b64_tr_b16 v[26:27], v90 offset:29184
    ds_read_b64_tr_b16 v[28:29], v91 offset:28672
    ds_read_b64_tr_b16 v[30:31], v91 offset:29184
    s_waitcnt lgkmcnt(12)
    v_mfma_f32_32x32x16_bf16 v[32:47], v[176:179], v[8:11], v[32:47]
    s_waitcnt lgkmcnt(10)
    v_mfma_f32_32x32x16_bf16 v[48:63], v[176:179], v[12:15], v[48:63]
    ds_read_b128 v[188:191], v87 offset:8192
    ds_read_b64_tr_b16 v[8:9], v90 offset:30720
    ds_read_b64_tr_b16 v[10:11], v90 offset:31232
    ds_read_b64_tr_b16 v[12:13], v91 offset:30720
    ds_read_b64_tr_b16 v[14:15], v91 offset:31232
    s_waitcnt lgkmcnt(12)
    v_mfma_f32_32x32x16_bf16 v[32:47], v[180:183], v[16:19], v[32:47]
    s_waitcnt lgkmcnt(10)
    v_mfma_f32_32x32x16_bf16 v[48:63], v[180:183], v[20:23], v[48:63]
    s_waitcnt lgkmcnt(7)
    v_mfma_f32_32x32x16_bf16 v[32:47], v[184:187], v[24:27], v[32:47]
    s_waitcnt lgkmcnt(5)
    v_mfma_f32_32x32x16_bf16 v[48:63], v[184:187], v[28:31], v[48:63]
    s_waitcnt lgkmcnt(0)
    s_barrier
    ds_read_b128 v[192:195], v80 offset:0
    ds_read_b64_tr_b16 v[16:17], v88 offset:16384
    ds_read_b64_tr_b16 v[18:19], v88 offset:16896
    ds_read_b64_tr_b16 v[20:21], v89 offset:16384
    ds_read_b64_tr_b16 v[22:23], v89 offset:16896
    ds_read_b128 v[196:199], v81 offset:0
    ds_read_b64_tr_b16 v[24:25], v88 offset:18432
    ds_read_b64_tr_b16 v[26:27], v88 offset:18944
    ds_read_b64_tr_b16 v[28:29], v89 offset:18432
    ds_read_b64_tr_b16 v[30:31], v89 offset:18944
    v_mfma_f32_32x32x16_bf16 v[32:47], v[188:191], v[8:11], v[32:47]
    v_mfma_f32_32x32x16_bf16 v[48:63], v[188:191], v[12:15], v[48:63]
    ds_read_b128 v[200:203], v82 offset:0
    ds_read_b64_tr_b16 v[8:9], v88 offset:20480
    ds_read_b64_tr_b16 v[10:11], v88 offset:20992
    ds_read_b64_tr_b16 v[12:13], v89 offset:20480
    ds_read_b64_tr_b16 v[14:15], v89 offset:20992
    s_waitcnt lgkmcnt(12)
    v_mfma_f32_32x32x16_bf16 v[32:47], v[192:195], v[16:19], v[32:47]
    s_waitcnt lgkmcnt(10)
    v_mfma_f32_32x32x16_bf16 v[48:63], v[192:195], v[20:23], v[48:63]
    ds_read_b128 v[204:207], v83 offset:0
    ds_read_b64_tr_b16 v[16:17], v88 offset:22528
    ds_read_b64_tr_b16 v[18:19], v88 offset:23040
    ds_read_b64_tr_b16 v[20:21], v89 offset:22528
    ds_read_b64_tr_b16 v[22:23], v89 offset:23040
    s_waitcnt lgkmcnt(12)
    v_mfma_f32_32x32x16_bf16 v[32:47], v[196:199], v[24:27], v[32:47]
    s_waitcnt lgkmcnt(10)
    v_mfma_f32_32x32x16_bf16 v[48:63], v[196:199], v[28:31], v[48:63]
    s_waitcnt lgkmcnt(7)
    v_mfma_f32_32x32x16_bf16 v[32:47], v[200:203], v[8:11], v[32:47]
    s_waitcnt lgkmcnt(5)
    v_mfma_f32_32x32x16_bf16 v[48:63], v[200:203], v[12:15], v[48:63]
    s_waitcnt lgkmcnt(0)
    s_barrier
    ds_read_b128 v[208:211], v80 offset:24576
    ds_read_b64_tr_b16 v[24:25], v88 offset:40960
    ds_read_b64_tr_b16 v[26:27], v88 offset:41472
    ds_read_b64_tr_b16 v[28:29], v89 offset:40960
    ds_read_b64_tr_b16 v[30:31], v89 offset:41472
    ds_read_b128 v[212:215], v81 offset:24576
    ds_read_b64_tr_b16 v[8:9], v88 offset:43008
    ds_read_b64_tr_b16 v[10:11], v88 offset:43520
    ds_read_b64_tr_b16 v[12:13], v89 offset:43008
    ds_read_b64_tr_b16 v[14:15], v89 offset:43520
    v_mfma_f32_32x32x16_bf16 v[32:47], v[204:207], v[16:19], v[32:47]
    v_mfma_f32_32x32x16_bf16 v[48:63], v[204:207], v[20:23], v[48:63]
    ds_read_b128 v[216:219], v82 offset:24576
    ds_read_b64_tr_b16 v[16:17], v88 offset:45056
    ds_read_b64_tr_b16 v[18:19], v88 offset:45568
    ds_read_b64_tr_b16 v[20:21], v89 offset:45056
    ds_read_b64_tr_b16 v[22:23], v89 offset:45568
    s_waitcnt lgkmcnt(12)
    v_mfma_f32_32x32x16_bf16 v[32:47], v[208:211], v[24:27], v[32:47]
    s_waitcnt lgkmcnt(10)
    v_mfma_f32_32x32x16_bf16 v[48:63], v[208:211], v[28:31], v[48:63]
    ds_read_b128 v[220:223], v83 offset:24576
    ds_read_b64_tr_b16 v[24:25], v88 offset:47104
    ds_read_b64_tr_b16 v[26:27], v88 offset:47616
    ds_read_b64_tr_b16 v[28:29], v89 offset:47104
    ds_read_b64_tr_b16 v[30:31], v89 offset:47616
    s_waitcnt lgkmcnt(12)
    v_mfma_f32_32x32x16_bf16 v[32:47], v[212:215], v[8:11], v[32:47]
    s_waitcnt lgkmcnt(10)
    v_mfma_f32_32x32x16_bf16 v[48:63], v[212:215], v[12:15], v[48:63]
    s_waitcnt lgkmcnt(7)
    v_mfma_f32_32x32x16_bf16 v[32:47], v[216:219], v[16:19], v[32:47]
    s_waitcnt lgkmcnt(5)
    v_mfma_f32_32x32x16_bf16 v[48:63], v[216:219], v[20:23], v[48:63]
    s_waitcnt lgkmcnt(0)
    s_barrier
    ds_read_b128 v[224:227], v80 offset:49152
    ds_read_b64_tr_b16 v[8:9], v90 offset:0
    ds_read_b64_tr_b16 v[10:11], v90 offset:512
    ds_read_b64_tr_b16 v[12:13], v91 offset:0
    ds_read_b64_tr_b16 v[14:15], v91 offset:512
    ds_read_b128 v[228:231], v81 offset:49152
    ds_read_b64_tr_b16 v[16:17], v90 offset:2048
    ds_read_b64_tr_b16 v[18:19], v90 offset:2560
    ds_read_b64_tr_b16 v[20:21], v91 offset:2048
    ds_read_b64_tr_b16 v[22:23], v91 offset:2560
    v_mfma_f32_32x32x16_bf16 v[32:47], v[220:223], v[24:27], v[32:47]
    v_mfma_f32_32x32x16_bf16 v[48:63], v[220:223], v[28:31], v[48:63]
    ds_read_b128 v[232:235], v82 offset:49152
    ds_read_b64_tr_b16 v[24:25], v90 offset:4096
    ds_read_b64_tr_b16 v[26:27], v90 offset:4608
    ds_read_b64_tr_b16 v[28:29], v91 offset:4096
    ds_read_b64_tr_b16 v[30:31], v91 offset:4608
    buffer_load_dword v94, v96, s[36:39], 0 offen sc1
    s_waitcnt lgkmcnt(12)
    v_mfma_f32_32x32x16_bf16 v[32:47], v[224:227], v[8:11], v[32:47]
    s_waitcnt lgkmcnt(10)
    v_mfma_f32_32x32x16_bf16 v[48:63], v[224:227], v[12:15], v[48:63]
    ds_read_b128 v[236:239], v83 offset:49152
    ds_read_b64_tr_b16 v[8:9], v90 offset:6144
    ds_read_b64_tr_b16 v[10:11], v90 offset:6656
    ds_read_b64_tr_b16 v[12:13], v91 offset:6144
    ds_read_b64_tr_b16 v[14:15], v91 offset:6656
    s_waitcnt lgkmcnt(12)
    v_mfma_f32_32x32x16_bf16 v[32:47], v[228:231], v[16:19], v[32:47]
    s_waitcnt lgkmcnt(10)
    v_mfma_f32_32x32x16_bf16 v[48:63], v[228:231], v[20:23], v[48:63]
    s_waitcnt lgkmcnt(7)
    v_mfma_f32_32x32x16_bf16 v[32:47], v[232:235], v[24:27], v[32:47]
    s_waitcnt lgkmcnt(5)
    v_mfma_f32_32x32x16_bf16 v[48:63], v[232:235], v[28:31], v[48:63]
    s_waitcnt lgkmcnt(0)
    v_mfma_f32_32x32x16_bf16 v[32:47], v[236:239], v[8:11], v[32:47]
    v_mfma_f32_32x32x16_bf16 v[48:63], v[236:239], v[12:15], v[48:63]
    s_barrier
    ds_read_b128 v[240:243], v84 offset:8192
    ds_read_b64_tr_b16 v[16:17], v90 offset:24576
    ds_read_b64_tr_b16 v[18:19], v90 offset:25088
    ds_read_b64_tr_b16 v[20:21], v91 offset:24576
    ds_read_b64_tr_b16 v[22:23], v91 offset:25088
    ds_read_b128 v[244:247], v85 offset:8192
    ds_read_b64_tr_b16 v[24:25], v90 offset:26624
    ds_read_b64_tr_b16 v[26:27], v90 offset:27136
    ds_read_b64_tr_b16 v[28:29], v91 offset:26624
    ds_read_b64_tr_b16 v[30:31], v91 offset:27136
    ds_read_b128 v[248:251], v86 offset:8192
    ds_read_b64_tr_b16 v[8:9], v90 offset:28672
    ds_read_b64_tr_b16 v[10:11], v90 offset:29184
    ds_read_b64_tr_b16 v[12:13], v91 offset:28672
    ds_read_b64_tr_b16 v[14:15], v91 offset:29184
    s_waitcnt lgkmcnt(12)
    v_mfma_f32_32x32x16_bf16 v[32:47], v[240:243], v[16:19], v[32:47]
    ds_read_b128 v[252:255], v87 offset:8192
    ds_read_b64_tr_b16 v[104:105], v90 offset:30720
    ds_read_b64_tr_b16 v[106:107], v90 offset:31232
    ds_read_b64_tr_b16 v[108:109], v91 offset:30720
    ds_read_b64_tr_b16 v[110:111], v91 offset:31232
    s_waitcnt lgkmcnt(12)
    v_mfma_f32_32x32x16_bf16 v[32:47], v[244:247], v[24:27], v[32:47]
    s_waitcnt lgkmcnt(7)
    v_mfma_f32_32x32x16_bf16 v[32:47], v[248:251], v[8:11], v[32:47]
    s_waitcnt lgkmcnt(2)
    v_mfma_f32_32x32x16_bf16 v[32:47], v[252:255], v[104:107], v[32:47]
    v_mfma_f32_32x32x16_bf16 v[48:63], v[240:243], v[20:23], v[48:63]
    s_nop 5
    v_mfma_f32_32x32x16_bf16 v[48:63], v[244:247], v[28:31], v[48:63]
    s_nop 3
    v_cvt_pk_bf16_f32 v112, v32, v33
    v_cvt_pk_bf16_f32 v113, v34, v35
    v_cvt_pk_bf16_f32 v114, v36, v37
    v_cvt_pk_bf16_f32 v115, v38, v39
    buffer_store_dwordx4 v[112:115], v93, s[40:43], s56 offen offset:0 sc1
    v_mfma_f32_32x32x16_bf16 v[48:63], v[248:251], v[12:15], v[48:63]
    s_waitcnt lgkmcnt(0)
    v_mfma_f32_32x32x16_bf16 v[48:63], v[252:255], v[108:111], v[48:63]
    v_cvt_pk_bf16_f32 v116, v40, v41
    v_cvt_pk_bf16_f32 v117, v42, v43
    v_cvt_pk_bf16_f32 v118, v44, v45
    v_cvt_pk_bf16_f32 v119, v46, v47
    buffer_store_dwordx4 v[116:119], v93, s[40:43], s56 offen offset:512 sc1
    s_add_u32 s56, s56, 262144
    s_nop 5
    v_cvt_pk_bf16_f32 v120, v48, v49
    v_cvt_pk_bf16_f32 v121, v50, v51
    v_cvt_pk_bf16_f32 v122, v52, v53
    v_cvt_pk_bf16_f32 v123, v54, v55
    buffer_store_dwordx4 v[120:123], v93, s[40:43], s56 offen offset:0 sc1
    v_cvt_pk_bf16_f32 v124, v56, v57
    v_cvt_pk_bf16_f32 v125, v58, v59
    v_cvt_pk_bf16_f32 v126, v60, v61
    v_cvt_pk_bf16_f32 v127, v62, v63
    buffer_store_dwordx4 v[124:127], v93, s[40:43], s56 offen offset:512 sc1
L_pass_q:
    s_lshr_b32 s54, s44, 1
    s_lshl_b32 s54, s54, 4
    s_add_u32 s54, s54, s45
    s_lshl_b32 s54, s54, 7
    s_add_u32 s54, s54, 12582912
    s_waitcnt vmcnt(4)
    v_cmp_gt_u32 vcc, 32, v94
    s_cbranch_vccz L_go_12
    s_mov_b32 s70, 100000
L_poll_13:
    buffer_load_dword v94, v96, s[36:39], 0 offen sc1
    s_waitcnt vmcnt(0)
    v_cmp_gt_u32 vcc, 32, v94
    s_cbranch_vccz L_pdone_14
    s_sleep 8
    s_sub_u32 s70, s70, 1
    s_cmp_lg_u32 s70, 0
    s_cbranch_scc1 L_poll_13
L_pdone_14:
L_go_12:
    s_barrier
    ds_read_b64_tr_b16 v[8:9], v92 offset:0
    ds_read_b64_tr_b16 v[10:11], v92 offset:256
    ds_read_b64_tr_b16 v[12:13], v92 offset:1024
    ds_read_b64_tr_b16 v[14:15], v92 offset:1280
    ds_read_b64_tr_b16 v[16:17], v92 offset:2048
    ds_read_b64_tr_b16 v[18:19], v92 offset:2304
    ds_read_b64_tr_b16 v[20:21], v92 offset:3072
    ds_read_b64_tr_b16 v[22:23], v92 offset:3328
    ds_read_b64_tr_b16 v[24:25], v92 offset:4096
    ds_read_b64_tr_b16 v[26:27], v92 offset:4352
    ds_read_b64_tr_b16 v[28:29], v92 offset:5120
    ds_read_b64_tr_b16 v[30:31], v92 offset:5376
    s_waitcnt lgkmcnt(10)
    v_mfma_f32_32x32x16_bf16 v[64:79], v[8:11], v[128:131], 0
    ds_read_b64_tr_b16 v[8:9], v92 offset:6144
    ds_read_b64_tr_b16 v[10:11], v92 offset:6400
    s_lshl_b32 s60, s44, 7
    s_mul_i32 s61, s47, 2064
    s_add_u32 s58, s51, 0
    s_and_b32 s58, s58, 3
    s_add_u32 s58, s58, s48
    s_mul_i32 s59, s58, 176128
    s_add_u32 s59, s59, s60
    s_add_u32 s58, s59, 22016
    s_add_u32 m0, s61, 0
    s_nop 0
    buffer_load_dwordx4 v2, s[16:19], s59 offen nt lds
    s_add_u32 m0, s61, 1024
    s_nop 0
    buffer_load_dwordx4 v2, s[16:19], s58 offen nt lds
    s_add_u32 m0, s61, 8256
    s_nop 0
    buffer_load_dwordx4 v2, s[20:23], s59 offen nt lds
    s_add_u32 m0, s61, 9280
    s_nop 0
    buffer_load_dwordx4 v2, s[20:23], s58 offen nt lds
    s_waitcnt lgkmcnt(10)
    v_mfma_f32_32x32x16_bf16 v[64:79], v[12:15], v[132:135], v[64:79]
    ds_read_b64_tr_b16 v[12:13], v92 offset:7168
    ds_read_b64_tr_b16 v[14:15], v92 offset:7424
    s_waitcnt lgkmcnt(10)
    v_mfma_f32_32x32x16_bf16 v[64:79], v[16:19], v[136:139], v[64:79]
    ds_read_b64_tr_b16 v[16:17], v92 offset:8192
    ds_read_b64_tr_b16 v[18:19], v92 offset:8448
    s_waitcnt lgkmcnt(10)
    v_mfma_f32_32x32x16_bf16 v[64:79], v[20:23], v[140:143], v[64:79]
    ds_read_b64_tr_b16 v[20:21], v92 offset:9216
    ds_read_b64_tr_b16 v[22:23], v92 offset:9472
    s_waitcnt lgkmcnt(10)
    v_mfma_f32_32x32x16_bf16 v[64:79], v[24:27], v[144:147], v[64:79]
    ds_read_b64_tr_b16 v[24:25], v92 offset:10240
    ds_read_b64_tr_b16 v[26:27], v92 offset:10496
    s_waitcnt lgkmcnt(10)
    v_mfma_f32_32x32x16_bf16 v[64:79], v[28:31], v[148:151], v[64:79]
    ds_read_b64_tr_b16 v[28:29], v92 offset:11264
    ds_read_b64_tr_b16 v[30:31], v92 offset:11520
    s_waitcnt lgkmcnt(10)
    v_mfma_f32_32x32x16_bf16 v[64:79], v[8:11], v[152:155], v[64:79]
    ds_read_b64_tr_b16 v[8:9], v92 offset:12288
    ds_read_b64_tr_b16 v[10:11], v92 offset:12544
    s_waitcnt lgkmcnt(10)
    v_mfma_f32_32x32x16_bf16 v[64:79], v[12:15], v[156:159], v[64:79]
    ds_read_b64_tr_b16 v[12:13], v92 offset:13312
    ds_read_b64_tr_b16 v[14:15], v92 offset:13568
    s_waitcnt lgkmcnt(10)
    v_mfma_f32_32x32x16_bf16 v[64:79], v[16:19], v[160:163], v[64:79]
    ds_read_b64_tr_b16 v[16:17], v92 offset:14336
    ds_read_b64_tr_b16 v[18:19], v92 offset:14592
    s_waitcnt lgkmcnt(10)
    v_mfma_f32_32x32x16_bf16 v[64:79], v[20:23], v[164:167], v[64:79]
    ds_read_b64_tr_b16 v[20:21], v92 offset:15360
    ds_read_b64_tr_b16 v[22:23], v92 offset:15616
    s_waitcnt lgkmcnt(10)
    v_mfma_f32_32x32x16_bf16 v[64:79], v[24:27], v[168:171], v[64:79]
    ds_read_b64_tr_b16 v[24:25], v92 offset:16384
    ds_read_b64_tr_b16 v[26:27], v92 offset:16640
    s_waitcnt lgkmcnt(10)
    v_mfma_f32_32x32x16_bf16 v[64:79], v[28:31], v[172:175], v[64:79]
    ds_read_b64_tr_b16 v[28:29], v92 offset:17408
    ds_read_b64_tr_b16 v[30:31], v92 offset:17664
    s_waitcnt lgkmcnt(10)
    v_mfma_f32_32x32x16_bf16 v[64:79], v[8:11], v[176:179], v[64:79]
    ds_read_b64_tr_b16 v[8:9], v92 offset:18432
    ds_read_b64_tr_b16 v[10:11], v92 offset:18688
    s_waitcnt vmcnt(4)
    s_atomic_add s71, s[40:41], s54
    s_mov_b64 exec, 1
    ds_add_u32 v5, v6 offset:48
    s_mov_b64 exec, -1
    s_waitcnt lgkmcnt(11)
    v_mfma_f32_32x32x16_bf16 v[64:79], v[12:15], v[180:183], v[64:79]
    ds_read_b64_tr_b16 v[12:13], v92 offset:19456
    ds_read_b64_tr_b16 v[14:15], v92 offset:19712
    s_waitcnt lgkmcnt(11)
    v_mfma_f32_32x32x16_bf16 v[64:79], v[16:19], v[184:187], v[64:79]
    ds_read_b64_tr_b16 v[16:17], v92 offset:20480
    ds_read_b64_tr_b16 v[18:19], v92 offset:20736
    s_waitcnt lgkmcnt(11)
    v_mfma_f32_32x32x16_bf16 v[64:79], v[20:23], v[188:191], v[64:79]
    ds_read_b64_tr_b16 v[20:21], v92 offset:21504
    ds_read_b64_tr_b16 v[22:23], v92 offset:21760
    s_waitcnt lgkmcnt(11)
    v_mfma_f32_32x32x16_bf16 v[64:79], v[24:27], v[192:195], v[64:79]
    ds_read_b64_tr_b16 v[24:25], v92 offset:22528
    ds_read_b64_tr_b16 v[26:27], v92 offset:22784
    s_waitcnt lgkmcnt(11)
    v_mfma_f32_32x32x16_bf16 v[64:79], v[28:31], v[196:199], v[64:79]
    ds_read_b64_tr_b16 v[28:29], v92 offset:23552
    ds_read_b64_tr_b16 v[30:31], v92 offset:23808
    s_waitcnt lgkmcnt(11)
    v_mfma_f32_32x32x16_bf16 v[64:79], v[8:11], v[200:203], v[64:79]
    ds_read_b64_tr_b16 v[8:9], v92 offset:24576
    ds_read_b64_tr_b16 v[10:11], v92 offset:24832
    s_waitcnt lgkmcnt(10)
    v_mfma_f32_32x32x16_bf16 v[64:79], v[12:15], v[204:207], v[64:79]
    ds_read_b64_tr_b16 v[12:13], v92 offset:25600
    ds_read_b64_tr_b16 v[14:15], v92 offset:25856
    s_waitcnt lgkmcnt(10)
    v_mfma_f32_32x32x16_bf16 v[64:79], v[16:19], v[208:211], v[64:79]
    ds_read_b64_tr_b16 v[16:17], v92 offset:26624
    ds_read_b64_tr_b16 v[18:19], v92 offset:26880
    s_waitcnt lgkmcnt(10)
    v_mfma_f32_32x32x16_bf16 v[64:79], v[20:23], v[212:215], v[64:79]
    ds_read_b64_tr_b16 v[20:21], v92 offset:27648
    ds_read_b64_tr_b16 v[22:23], v92 offset:27904
    s_waitcnt lgkmcnt(10)
    v_mfma_f32_32x32x16_bf16 v[64:79], v[24:27], v[216:219], v[64:79]
    ds_read_b64_tr_b16 v[24:25], v92 offset:28672
    ds_read_b64_tr_b16 v[26:27], v92 offset:28928
    s_waitcnt lgkmcnt(10)
    v_mfma_f32_32x32x16_bf16 v[64:79], v[28:31], v[220:223], v[64:79]
    ds_read_b64_tr_b16 v[28:29], v92 offset:29696
    ds_read_b64_tr_b16 v[30:31], v92 offset:29952
    s_waitcnt lgkmcnt(10)
    v_mfma_f32_32x32x16_bf16 v[64:79], v[8:11], v[224:227], v[64:79]
    ds_read_b64_tr_b16 v[8:9], v92 offset:30720
    ds_read_b64_tr_b16 v[10:11], v92 offset:30976
    s_waitcnt lgkmcnt(10)
    v_mfma_f32_32x32x16_bf16 v[64:79], v[12:15], v[228:231], v[64:79]
    ds_read_b64_tr_b16 v[12:13], v92 offset:31744
    ds_read_b64_tr_b16 v[14:15], v92 offset:32000
    s_waitcnt lgkmcnt(10)
    v_mfma_f32_32x32x16_bf16 v[64:79], v[16:19], v[232:235], v[64:79]
    s_waitcnt lgkmcnt(8)
    v_mfma_f32_32x32x16_bf16 v[64:79], v[20:23], v[236:239], v[64:79]
    s_waitcnt lgkmcnt(6)
    v_mfma_f32_32x32x16_bf16 v[64:79], v[24:27], v[240:243], v[64:79]
    s_waitcnt lgkmcnt(4)
    v_mfma_f32_32x32x16_bf16 v[64:79], v[28:31], v[244:247], v[64:79]
    s_waitcnt lgkmcnt(2)
    v_mfma_f32_32x32x16_bf16 v[64:79], v[8:11], v[248:251], v[64:79]
    s_waitcnt lgkmcnt(0)
    v_mfma_f32_32x32x16_bf16 v[64:79], v[12:15], v[252:255], v[64:79]
    v_mov_b32 v98, 0x3eb8aa3b
    s_nop 10
    v_pk_mul_f32 v[64:65], v[64:65], v[98:99] op_sel_hi:[1,0]
    v_pk_mul_f32 v[66:67], v[66:67], v[98:99] op_sel_hi:[1,0]
    v_pk_mul_f32 v[68:69], v[68:69], v[98:99] op_sel_hi:[1,0]
    v_pk_mul_f32 v[70:71], v[70:71], v[98:99] op_sel_hi:[1,0]
    v_pk_mul_f32 v[72:73], v[72:73], v[98:99] op_sel_hi:[1,0]
    v_pk_mul_f32 v[74:75], v[74:75], v[98:99] op_sel_hi:[1,0]
    v_pk_mul_f32 v[76:77], v[76:77], v[98:99] op_sel_hi:[1,0]
    v_pk_mul_f32 v[78:79], v[78:79], v[98:99] op_sel_hi:[1,0]
    v_cvt_pk_bf16_f32 v64, v64, v65
    v_cvt_pk_bf16_f32 v65, v66, v67
    v_cvt_pk_bf16_f32 v66, v68, v69
    v_cvt_pk_bf16_f32 v67, v70, v71
    ds_write_b128 v95, v[64:67] offset:0
    v_cvt_pk_bf16_f32 v68, v72, v73
    v_cvt_pk_bf16_f32 v69, v74, v75
    v_cvt_pk_bf16_f32 v70, v76, v77
    v_cvt_pk_bf16_f32 v71, v78, v79
    ds_write_b128 v95, v[68:71] offset:4096
    s_mov_b64 exec, 1
    ds_add_u32 v5, v6 offset:16
    s_mov_b64 exec, -1
    s_setprio 3
    v_permlane16_swap_b32 v128, v132
    v_permlane16_swap_b32 v129, v133
    v_permlane16_swap_b32 v130, v134
    v_permlane16_swap_b32 v131, v135
    v_permlane16_swap_b32 v136, v140
    v_permlane16_swap_b32 v137, v141
    v_permlane16_swap_b32 v138, v142
    v_permlane16_swap_b32 v139, v143
    v_permlane16_swap_b32 v144, v148
    v_permlane16_swap_b32 v145, v149
    v_permlane16_swap_b32 v146, v150
    v_permlane16_swap_b32 v147, v151
    v_permlane16_swap_b32 v152, v156
    v_permlane16_swap_b32 v153, v157
    v_permlane16_swap_b32 v154, v158
    v_permlane16_swap_b32 v155, v159
    v_permlane16_swap_b32 v160, v164
    v_permlane16_swap_b32 v161, v165
    v_permlane16_swap_b32 v162, v166
    v_permlane16_swap_b32 v163, v167
    v_permlane16_swap_b32 v168, v172
    v_permlane16_swap_b32 v169, v173
    v_permlane16_swap_b32 v170, v174
    v_permlane16_swap_b32 v171, v175
    v_permlane16_swap_b32 v176, v180
    v_permlane16_swap_b32 v177, v181
    v_permlane16_swap_b32 v178, v182
    v_permlane16_swap_b32 v179, v183
    v_permlane16_swap_b32 v184, v188
    v_permlane16_swap_b32 v185, v189
    v_permlane16_swap_b32 v186, v190
    v_permlane16_swap_b32 v187, v191
    v_permlane16_swap_b32 v192, v196
    v_permlane16_swap_b32 v193, v197
    v_permlane16_swap_b32 v194, v198
    v_permlane16_swap_b32 v195, v199
    v_permlane16_swap_b32 v200, v204
    v_permlane16_swap_b32 v201, v205
    v_permlane16_swap_b32 v202, v206
    v_permlane16_swap_b32 v203, v207
    v_permlane16_swap_b32 v208, v212
    v_permlane16_swap_b32 v209, v213
    v_permlane16_swap_b32 v210, v214
    v_permlane16_swap_b32 v211, v215
    v_permlane16_swap_b32 v216, v220
    v_permlane16_swap_b32 v217, v221
    v_permlane16_swap_b32 v218, v222
    v_permlane16_swap_b32 v219, v223
    v_permlane16_swap_b32 v224, v228
    v_permlane16_swap_b32 v225, v229
    v_permlane16_swap_b32 v226, v230
    v_permlane16_swap_b32 v227, v231
    v_permlane16_swap_b32 v232, v236
    v_permlane16_swap_b32 v233, v237
    v_permlane16_swap_b32 v234, v238
    v_permlane16_swap_b32 v235, v239
    v_permlane16_swap_b32 v240, v244
    v_permlane16_swap_b32 v241, v245
    v_permlane16_swap_b32 v242, v246
    v_permlane16_swap_b32 v243, v247
    v_permlane16_swap_b32 v248, v252
    v_permlane16_swap_b32 v249, v253
    v_permlane16_swap_b32 v250, v254
    v_permlane16_swap_b32 v251, v255
    ds_read_b32 v7, v5 offset:20
    s_waitcnt lgkmcnt(0)
    v_cmp_gt_u32 vcc, 4, v7
    s_cbranch_vccz L_ldone_16
    s_mov_b32 s70, 1000000
L_lspin_15:
    ds_read_b32 v7, v5 offset:20
    s_waitcnt lgkmcnt(0)
    v_cmp_gt_u32 vcc, 4, v7
    s_cbranch_vccz L_ldone_16
    s_sub_u32 s70, s70, 1
    s_cmp_lg_u32 s70, 0
    s_cbranch_scc1 L_lspin_15
L_ldone_16:
    s_add_u32 s58, s51, 1
    s_and_b32 s58, s58, 3
    s_add_u32 s58, s58, s48
    s_mul_i32 s59, s58, 176128
    s_add_u32 s59, s59, s60
    s_add_u32 s58, s59, 22016
    s_add_u32 m0, s61, 16512
    s_nop 0
    buffer_load_dwordx4 v2, s[16:19], s59 offen  lds
    s_add_u32 m0, s61, 17536
    s_nop 0
    buffer_load_dwordx4 v2, s[16:19], s58 offen  lds
    s_add_u32 m0, s61, 24768
    s_nop 0
    buffer_load_dwordx4 v2, s[20:23], s59 offen  lds
    s_add_u32 m0, s61, 25792
    s_nop 0
    buffer_load_dwordx4 v2, s[20:23], s58 offen  lds
    s_waitcnt vmcnt(4)
    s_mov_b64 exec, 1
    ds_add_u32 v5, v6 offset:0
    s_mov_b64 exec, -1
    ds_read_b32 v7, v5 offset:0
    s_waitcnt lgkmcnt(0)
    v_cmp_gt_u32 vcc, 16, v7
    s_cbranch_vccz L_ldone_18
    s_mov_b32 s70, 1000000
L_lspin_17:
    ds_read_b32 v7, v5 offset:0
    s_waitcnt lgkmcnt(0)
    v_cmp_gt_u32 vcc, 16, v7
    s_cbranch_vccz L_ldone_18
    s_sub_u32 s70, s70, 1
    s_cmp_lg_u32 s70, 0
    s_cbranch_scc1 L_lspin_17
L_ldone_18:
    s_setprio 0
    ds_read_b64_tr_b16 v[8:9], v0 offset:0
    ds_read_b64_tr_b16 v[10:11], v0 offset:256
    ds_read_b64_tr_b16 v[12:13], v0 offset:16
    ds_read_b64_tr_b16 v[14:15], v0 offset:272
    ds_read_b64_tr_b16 v[16:17], v0 offset:8256
    ds_read_b64_tr_b16 v[18:19], v0 offset:8512
    ds_read_b64_tr_b16 v[20:21], v0 offset:8272
    ds_read_b64_tr_b16 v[22:23], v0 offset:8528
    ds_read_b64_tr_b16 v[24:25], v0 offset:512
    ds_read_b64_tr_b16 v[26:27], v0 offset:768
    ds_read_b64_tr_b16 v[28:29], v0 offset:528
    ds_read_b64_tr_b16 v[30:31], v0 offset:784
    s_waitcnt lgkmcnt(10)
    v_mfma_f32_16x16x32_bf16 v[32:35], v[8:11], v[128:131], 0
    v_mfma_f32_16x16x32_bf16 v[40:43], v[8:11], v[132:135], 0
    ds_read_b64_tr_b16 v[8:9], v0 offset:8768
    s_waitcnt lgkmcnt(9)
    v_mfma_f32_16x16x32_bf16 v[36:39], v[12:15], v[128:131], 0
    ds_read_b64_tr_b16 v[10:11], v0 offset:9024
    v_mfma_f32_16x16x32_bf16 v[44:47], v[12:15], v[132:135], 0
    ds_read_b64_tr_b16 v[12:13], v0 offset:8784
    s_waitcnt lgkmcnt(9)
    v_mfma_f32_16x16x32_bf16 v[48:51], v[16:19], v[128:131], 0
    ds_read_b64_tr_b16 v[14:15], v0 offset:9040
    v_mfma_f32_16x16x32_bf16 v[56:59], v[16:19], v[132:135], 0
    ds_read_b64_tr_b16 v[16:17], v0 offset:4128
    s_waitcnt lgkmcnt(9)
    v_mfma_f32_16x16x32_bf16 v[52:55], v[20:23], v[128:131], 0
    ds_read_b64_tr_b16 v[18:19], v0 offset:4384
    v_mfma_f32_16x16x32_bf16 v[60:63], v[20:23], v[132:135], 0
    ds_read_b64_tr_b16 v[20:21], v0 offset:4144
    s_waitcnt lgkmcnt(9)
    v_mfma_f32_16x16x32_bf16 v[64:67], v[24:27], v[128:131], 0
    ds_read_b64_tr_b16 v[22:23], v0 offset:4400
    v_mfma_f32_16x16x32_bf16 v[72:75], v[24:27], v[132:135], 0
    ds_read_b64_tr_b16 v[24:25], v0 offset:12384
    s_waitcnt lgkmcnt(9)
    v_mfma_f32_16x16x32_bf16 v[68:71], v[28:31], v[128:131], 0
    ds_read_b64_tr_b16 v[26:27], v0 offset:12640
    v_mfma_f32_16x16x32_bf16 v[76:79], v[28:31], v[132:135], 0
    ds_read_b64_tr_b16 v[28:29], v0 offset:12400
    s_waitcnt lgkmcnt(9)
    v_mfma_f32_16x16x32_bf16 v[80:83], v[8:11], v[128:131], 0
    ds_read_b64_tr_b16 v[30:31], v0 offset:12656
    v_mfma_f32_16x16x32_bf16 v[88:91], v[8:11], v[132:135], 0
    ds_read_b64_tr_b16 v[8:9], v0 offset:4640
    s_waitcnt lgkmcnt(9)
    v_mfma_f32_16x16x32_bf16 v[84:87], v[12:15], v[128:131], 0
    ds_read_b64_tr_b16 v[10:11], v0 offset:4896
    v_mfma_f32_16x16x32_bf16 v[92:95], v[12:15], v[132:135], 0
    s_waitcnt vmcnt(0)
    s_mov_b64 exec, 1
    ds_add_u32 v5, v6 offset:0
    s_mov_b64 exec, -1
    s_add_u32 s58, s51, 2
    s_and_b32 s58, s58, 3
    s_add_u32 s58, s58, s48
    s_mul_i32 s59, s58, 176128
    s_add_u32 s59, s59, s60
    s_add_u32 s58, s59, 22016
    s_add_u32 m0, s61, 33024
    s_nop 0
    buffer_load_dwordx4 v2, s[16:19], s59 offen  lds
    s_add_u32 m0, s61, 34048
    s_nop 0
    buffer_load_dwordx4 v2, s[16:19], s58 offen  lds
    s_add_u32 m0, s61, 41280
    s_nop 0
    buffer_load_dwordx4 v2, s[20:23], s59 offen  lds
    s_add_u32 m0, s61, 42304
    s_nop 0
    buffer_load_dwordx4 v2, s[20:23], s58 offen  lds
    ds_read_b64_tr_b16 v[12:13], v0 offset:4656
    s_waitcnt lgkmcnt(10)
    v_mfma_f32_16x16x32_bf16 v[32:35], v[16:19], v[136:139], v[32:35]
    ds_read_b64_tr_b16 v[14:15], v0 offset:4912
    v_mfma_f32_16x16x32_bf16 v[40:43], v[16:19], v[140:143], v[40:43]
    ds_read_b32 v7, v5 offset:0
    ds_read_b64_tr_b16 v[16:17], v0 offset:12896
    s_waitcnt lgkmcnt(11)
    v_mfma_f32_16x16x32_bf16 v[36:39], v[20:23], v[136:139], v[36:39]
    ds_read_b64_tr_b16 v[18:19], v0 offset:13152
    v_mfma_f32_16x16x32_bf16 v[44:47], v[20:23], v[140:143], v[44:47]
    ds_read_b64_tr_b16 v[20:21], v0 offset:12912
    s_waitcnt lgkmcnt(11)
    v_mfma_f32_16x16x32_bf16 v[48:51], v[24:27], v[136:139], v[48:51]
    ds_read_b64_tr_b16 v[22:23], v0 offset:13168
    v_mfma_f32_16x16x32_bf16 v[56:59], v[24:27], v[140:143], v[56:59]
    s_waitcnt lgkmcnt(4)
    v_cmp_gt_u32 vcc, 32, v7
    s_cbranch_vccz L_ldone_20
    s_mov_b32 s70, 1000000
L_lspin_19:
    ds_read_b32 v7, v5 offset:0
    s_waitcnt lgkmcnt(0)
    v_cmp_gt_u32 vcc, 32, v7
    s_cbranch_vccz L_ldone_20
    s_sub_u32 s70, s70, 1
    s_cmp_lg_u32 s70, 0
    s_cbranch_scc1 L_lspin_19
L_ldone_20:
    ds_read_b64_tr_b16 v[24:25], v0 offset:16512
    v_mfma_f32_16x16x32_bf16 v[52:55], v[28:31], v[136:139], v[52:55]
    ds_read_b64_tr_b16 v[26:27], v0 offset:16768
    v_mfma_f32_16x16x32_bf16 v[60:63], v[28:31], v[140:143], v[60:63]
    ds_read_b64_tr_b16 v[28:29], v0 offset:16528
    v_mfma_f32_16x16x32_bf16 v[64:67], v[8:11], v[136:139], v[64:67]
    ds_read_b64_tr_b16 v[30:31], v0 offset:16784
    v_mfma_f32_16x16x32_bf16 v[72:75], v[8:11], v[140:143], v[72:75]
    ds_read_b64_tr_b16 v[8:9], v0 offset:24768
    v_mfma_f32_16x16x32_bf16 v[68:71], v[12:15], v[136:139], v[68:71]
    ds_read_b64_tr_b16 v[10:11], v0 offset:25024
    v_mfma_f32_16x16x32_bf16 v[76:79], v[12:15], v[140:143], v[76:79]
    ds_read_b64_tr_b16 v[12:13], v0 offset:24784
    s_waitcnt lgkmcnt(9)
    v_mfma_f32_16x16x32_bf16 v[80:83], v[16:19], v[136:139], v[80:83]
    ds_read_b64_tr_b16 v[14:15], v0 offset:25040
    v_mfma_f32_16x16x32_bf16 v[88:91], v[16:19], v[140:143], v[88:91]
    ds_read_b64_tr_b16 v[16:17], v0 offset:17024
    s_waitcnt lgkmcnt(9)
    v_mfma_f32_16x16x32_bf16 v[84:87], v[20:23], v[136:139], v[84:87]
    ds_read_b64_tr_b16 v[18:19], v0 offset:17280
    v_mfma_f32_16x16x32_bf16 v[92:95], v[20:23], v[140:143], v[92:95]
    ds_read_b64_tr_b16 v[20:21], v0 offset:17040
    s_waitcnt lgkmcnt(9)
    v_mfma_f32_16x16x32_bf16 v[32:35], v[24:27], v[144:147], v[32:35]
    ds_read_b64_tr_b16 v[22:23], v0 offset:17296
    v_mfma_f32_16x16x32_bf16 v[40:43], v[24:27], v[148:151], v[40:43]
    ds_read_b64_tr_b16 v[24:25], v0 offset:25280
    s_waitcnt lgkmcnt(9)
    v_mfma_f32_16x16x32_bf16 v[36:39], v[28:31], v[144:147], v[36:39]
    ds_read_b64_tr_b16 v[26:27], v0 offset:25536
    v_mfma_f32_16x16x32_bf16 v[44:47], v[28:31], v[148:151], v[44:47]
    ds_read_b32 v7, v5 offset:24
    ds_read_b64_tr_b16 v[28:29], v0 offset:25296
    s_waitcnt lgkmcnt(10)
    v_mfma_f32_16x16x32_bf16 v[48:51], v[8:11], v[144:147], v[48:51]
    ds_read_b64_tr_b16 v[30:31], v0 offset:25552
    v_mfma_f32_16x16x32_bf16 v[56:59], v[8:11], v[148:151], v[56:59]
    ds_read_b64_tr_b16 v[8:9], v0 offset:20640
    s_waitcnt lgkmcnt(10)
    v_mfma_f32_16x16x32_bf16 v[52:55], v[12:15], v[144:147], v[52:55]
    ds_read_b64_tr_b16 v[10:11], v0 offset:20896
    v_mfma_f32_16x16x32_bf16 v[60:63], v[12:15], v[148:151], v[60:63]
    s_waitcnt lgkmcnt(4)
    v_cmp_gt_u32 vcc, 4, v7
    s_cbranch_vccz L_ldone_22
    s_mov_b32 s70, 1000000
L_lspin_21:
    ds_read_b32 v7, v5 offset:24
    s_waitcnt lgkmcnt(0)
    v_cmp_gt_u32 vcc, 4, v7
    s_cbranch_vccz L_ldone_22
    s_sub_u32 s70, s70, 1
    s_cmp_lg_u32 s70, 0
    s_cbranch_scc1 L_lspin_21
L_ldone_22:
    ds_read_b64_tr_b16 v[12:13], v0 offset:20656
    v_mfma_f32_16x16x32_bf16 v[64:67], v[16:19], v[144:147], v[64:67]
    ds_read_b64_tr_b16 v[14:15], v0 offset:20912
    v_mfma_f32_16x16x32_bf16 v[72:75], v[16:19], v[148:151], v[72:75]
    s_waitcnt vmcnt(0)
    s_mov_b64 exec, 1
    ds_add_u32 v5, v6 offset:0
    s_mov_b64 exec, -1
    s_add_u32 s58, s51, 3
    s_and_b32 s58, s58, 3
    s_add_u32 s58, s58, s48
    s_mul_i32 s59, s58, 176128
    s_add_u32 s59, s59, s60
    s_add_u32 s58, s59, 22016
    s_add_u32 m0, s61, 49536
    s_nop 0
    buffer_load_dwordx4 v2, s[16:19], s59 offen  lds
    s_add_u32 m0, s61, 50560
    s_nop 0
    buffer_load_dwordx4 v2, s[16:19], s58 offen  lds
    s_add_u32 m0, s61, 57792
    s_nop 0
    buffer_load_dwordx4 v2, s[20:23], s59 offen  lds
    s_add_u32 m0, s61, 58816
    s_nop 0
    buffer_load_dwordx4 v2, s[20:23], s58 offen  lds
    ds_read_b64_tr_b16 v[16:17], v0 offset:28896
    v_mfma_f32_16x16x32_bf16 v[68:71], v[20:23], v[144:147], v[68:71]
    ds_read_b64_tr_b16 v[18:19], v0 offset:29152
    v_mfma_f32_16x16x32_bf16 v[76:79], v[20:23], v[148:151], v[76:79]
    ds_read_b64_tr_b16 v[20:21], v0 offset:28912
    v_mfma_f32_16x16x32_bf16 v[80:83], v[24:27], v[144:147], v[80:83]
    ds_read_b64_tr_b16 v[22:23], v0 offset:29168
    v_mfma_f32_16x16x32_bf16 v[88:91], v[24:27], v[148:151], v[88:91]
    ds_read_b64_tr_b16 v[24:25], v0 offset:21152
    s_waitcnt lgkmcnt(10)
    v_mfma_f32_16x16x32_bf16 v[84:87], v[28:31], v[144:147], v[84:87]
    ds_read_b64_tr_b16 v[26:27], v0 offset:21408
    v_mfma_f32_16x16x32_bf16 v[92:95], v[28:31], v[148:151], v[92:95]
    ds_read_b64_tr_b16 v[28:29], v0 offset:21168
    s_waitcnt lgkmcnt(10)
    v_mfma_f32_16x16x32_bf16 v[32:35], v[8:11], v[152:155], v[32:35]
    ds_read_b64_tr_b16 v[30:31], v0 offset:21424
    v_mfma_f32_16x16x32_bf16 v[40:43], v[8:11], v[156:159], v[40:43]
    ds_read_b32 v7, v5 offset:0
    ds_read_b64_tr_b16 v[8:9], v0 offset:29408
    s_waitcnt lgkmcnt(11)
    v_mfma_f32_16x16x32_bf16 v[36:39], v[12:15], v[152:155], v[36:39]
    ds_read_b64_tr_b16 v[10:11], v0 offset:29664
    v_mfma_f32_16x16x32_bf16 v[44:47], v[12:15], v[156:159], v[44:47]
    ds_read_b64_tr_b16 v[12:13], v0 offset:29424
    s_waitcnt lgkmcnt(10)
    v_mfma_f32_16x16x32_bf16 v[48:51], v[16:19], v[152:155], v[48:51]
    ds_read_b64_tr_b16 v[14:15], v0 offset:29680
    v_mfma_f32_16x16x32_bf16 v[56:59], v[16:19], v[156:159], v[56:59]
    s_waitcnt lgkmcnt(4)
    v_cmp_gt_u32 vcc, 48, v7
    s_cbranch_vccz L_ldone_24
    s_mov_b32 s70, 1000000
L_lspin_23:
    ds_read_b32 v7, v5 offset:0
    s_waitcnt lgkmcnt(0)
    v_cmp_gt_u32 vcc, 48, v7
    s_cbranch_vccz L_ldone_24
    s_sub_u32 s70, s70, 1
    s_cmp_lg_u32 s70, 0
    s_cbranch_scc1 L_lspin_23
L_ldone_24:
    ds_read_b64_tr_b16 v[16:17], v0 offset:33024
    v_mfma_f32_16x16x32_bf16 v[52:55], v[20:23], v[152:155], v[52:55]
    ds_read_b64_tr_b16 v[18:19], v0 offset:33280
    v_mfma_f32_16x16x32_bf16 v[60:63], v[20:23], v[156:159], v[60:63]
    ds_read_b64_tr_b16 v[20:21], v0 offset:33040
    v_mfma_f32_16x16x32_bf16 v[64:67], v[24:27], v[152:155], v[64:67]
    ds_read_b64_tr_b16 v[22:23], v0 offset:33296
    v_mfma_f32_16x16x32_bf16 v[72:75], v[24:27], v[156:159], v[72:75]
    s_lshr_b32 s62, s2, 3
    s_lshl_b32 s62, s62, 2
    s_add_u32 s62, s62, s47
    s_mul_i32 s62, s62, 11008
    s_add_u32 s62, s62, 0
    s_mov_b32 m0, 158272
    s_mov_b64 exec, 0xffff
    buffer_load_dword v6, s[24:27], s62 offen lds
    s_mov_b64 exec, -1
    s_lshl_b32 s62, s47, 17
    s_lshl_b32 s63, s50, 7
    s_add_u32 s62, s62, s63
    s_lshl_b32 s63, s47, 14
    s_add_u32 m0, s63, 74240
    s_add_u32 s62, s62, 0
    buffer_load_dwordx4 v1, s[12:15], s62 offen lds
    s_add_u32 m0, s63, 75264
    s_add_u32 s62, s62, 8192
    buffer_load_dwordx4 v1, s[12:15], s62 offen lds
    s_add_u32 m0, s63, 76288
    s_add_u32 s62, s62, 8192
    buffer_load_dwordx4 v1, s[12:15], s62 offen lds
    ds_read_b64_tr_b16 v[24:25], v0 offset:41280
    v_mfma_f32_16x16x32_bf16 v[68:71], v[28:31], v[152:155], v[68:71]
    ds_read_b64_tr_b16 v[26:27], v0 offset:41536
    v_mfma_f32_16x16x32_bf16 v[76:79], v[28:31], v[156:159], v[76:79]
    ds_read_b64_tr_b16 v[28:29], v0 offset:41296
    s_waitcnt lgkmcnt(9)
    v_mfma_f32_16x16x32_bf16 v[80:83], v[8:11], v[152:155], v[80:83]
    ds_read_b64_tr_b16 v[30:31], v0 offset:41552
    v_mfma_f32_16x16x32_bf16 v[88:91], v[8:11], v[156:159], v[88:91]
    ds_read_b64_tr_b16 v[8:9], v0 offset:33536
    s_waitcnt lgkmcnt(9)
    v_mfma_f32_16x16x32_bf16 v[84:87], v[12:15], v[152:155], v[84:87]
    ds_read_b64_tr_b16 v[10:11], v0 offset:33792
    v_mfma_f32_16x16x32_bf16 v[92:95], v[12:15], v[156:159], v[92:95]
    ds_read_b64_tr_b16 v[12:13], v0 offset:33552
    s_waitcnt lgkmcnt(9)
    v_mfma_f32_16x16x32_bf16 v[32:35], v[16:19], v[160:163], v[32:35]
    ds_read_b64_tr_b16 v[14:15], v0 offset:33808
    v_mfma_f32_16x16x32_bf16 v[40:43], v[16:19], v[164:167], v[40:43]
    ds_read_b64_tr_b16 v[16:17], v0 offset:41792
    s_waitcnt lgkmcnt(9)
    v_mfma_f32_16x16x32_bf16 v[36:39], v[20:23], v[160:163], v[36:39]
    ds_read_b64_tr_b16 v[18:19], v0 offset:42048
    v_mfma_f32_16x16x32_bf16 v[44:47], v[20:23], v[164:167], v[44:47]
    ds_read_b64_tr_b16 v[20:21], v0 offset:41808
    s_waitcnt lgkmcnt(9)
    v_mfma_f32_16x16x32_bf16 v[48:51], v[24:27], v[160:163], v[48:51]
    ds_read_b64_tr_b16 v[22:23], v0 offset:42064
    v_mfma_f32_16x16x32_bf16 v[56:59], v[24:27], v[164:167], v[56:59]
    ds_read_b64_tr_b16 v[24:25], v0 offset:37152
    s_waitcnt lgkmcnt(9)
    v_mfma_f32_16x16x32_bf16 v[52:55], v[28:31], v[160:163], v[52:55]
    ds_read_b64_tr_b16 v[26:27], v0 offset:37408
    v_mfma_f32_16x16x32_bf16 v[60:63], v[28:31], v[164:167], v[60:63]
    ds_read_b64_tr_b16 v[28:29], v0 offset:37168
    s_waitcnt lgkmcnt(9)
    v_mfma_f32_16x16x32_bf16 v[64:67], v[8:11], v[160:163], v[64:67]
    ds_read_b64_tr_b16 v[30:31], v0 offset:37424
    v_mfma_f32_16x16x32_bf16 v[72:75], v[8:11], v[164:167], v[72:75]
    s_waitcnt vmcnt(4)
    s_mov_b64 exec, 1
    ds_add_u32 v5, v6 offset:0
    s_mov_b64 exec, -1
    s_add_u32 s58, s51, 0
    s_and_b32 s58, s58, 3
    s_add_u32 s58, s58, s48
    s_xor_b32 s58, s58, 4
    s_mul_i32 s59, s58, 176128
    s_add_u32 s59, s59, s60
    s_add_u32 s58, s59, 22016
    s_add_u32 m0, s61, 0
    s_nop 0
    buffer_load_dwordx4 v2, s[16:19], s59 offen nt lds
    s_add_u32 m0, s61, 1024
    s_nop 0
    buffer_load_dwordx4 v2, s[16:19], s58 offen nt lds
    s_add_u32 m0, s61, 8256
    s_nop 0
    buffer_load_dwordx4 v2, s[20:23], s59 offen nt lds
    s_add_u32 m0, s61, 9280
    s_nop 0
    buffer_load_dwordx4 v2, s[20:23], s58 offen nt lds
    ds_read_b64_tr_b16 v[8:9], v0 offset:45408
    s_waitcnt lgkmcnt(10)
    v_mfma_f32_16x16x32_bf16 v[68:71], v[12:15], v[160:163], v[68:71]
    ds_read_b64_tr_b16 v[10:11], v0 offset:45664
    v_mfma_f32_16x16x32_bf16 v[76:79], v[12:15], v[164:167], v[76:79]
    ds_read_b64_tr_b16 v[12:13], v0 offset:45424
    s_waitcnt lgkmcnt(10)
    v_mfma_f32_16x16x32_bf16 v[80:83], v[16:19], v[160:163], v[80:83]
    ds_read_b64_tr_b16 v[14:15], v0 offset:45680
    v_mfma_f32_16x16x32_bf16 v[88:91], v[16:19], v[164:167], v[88:91]
    ds_read_b64_tr_b16 v[16:17], v0 offset:37664
    s_waitcnt lgkmcnt(10)
    v_mfma_f32_16x16x32_bf16 v[84:87], v[20:23], v[160:163], v[84:87]
    ds_read_b64_tr_b16 v[18:19], v0 offset:37920
    v_mfma_f32_16x16x32_bf16 v[92:95], v[20:23], v[164:167], v[92:95]
    ds_read_b64_tr_b16 v[20:21], v0 offset:37680
    s_waitcnt lgkmcnt(10)
    v_mfma_f32_16x16x32_bf16 v[32:35], v[24:27], v[168:171], v[32:35]
    ds_read_b64_tr_b16 v[22:23], v0 offset:37936
    v_mfma_f32_16x16x32_bf16 v[40:43], v[24:27], v[172:175], v[40:43]
    ds_read_b32 v7, v5 offset:0
    ds_read_b64_tr_b16 v[24:25], v0 offset:45920
    s_waitcnt lgkmcnt(11)
    v_mfma_f32_16x16x32_bf16 v[36:39], v[28:31], v[168:171], v[36:39]
    ds_read_b64_tr_b16 v[26:27], v0 offset:46176
    v_mfma_f32_16x16x32_bf16 v[44:47], v[28:31], v[172:175], v[44:47]
    ds_read_b64_tr_b16 v[28:29], v0 offset:45936
    s_waitcnt lgkmcnt(10)
    v_mfma_f32_16x16x32_bf16 v[48:51], v[8:11], v[168:171], v[48:51]
    ds_read_b64_tr_b16 v[30:31], v0 offset:46192
    v_mfma_f32_16x16x32_bf16 v[56:59], v[8:11], v[172:175], v[56:59]
    s_waitcnt lgkmcnt(4)
    v_cmp_gt_u32 vcc, 64, v7
    s_cbranch_vccz L_ldone_26
    s_mov_b32 s70, 1000000
L_lspin_25:
    ds_read_b32 v7, v5 offset:0
    s_waitcnt lgkmcnt(0)
    v_cmp_gt_u32 vcc, 64, v7
    s_cbranch_vccz L_ldone_26
    s_sub_u32 s70, s70, 1
    s_cmp_lg_u32 s70, 0
    s_cbranch_scc1 L_lspin_25
L_ldone_26:
    ds_read_b64_tr_b16 v[8:9], v0 offset:49536
    v_mfma_f32_16x16x32_bf16 v[52:55], v[12:15], v[168:171], v[52:55]
    ds_read_b64_tr_b16 v[10:11], v0 offset:49792
    v_mfma_f32_16x16x32_bf16 v[60:63], v[12:15], v[172:175], v[60:63]
    ds_read_b64_tr_b16 v[12:13], v0 offset:49552
    v_mfma_f32_16x16x32_bf16 v[64:67], v[16:19], v[168:171], v[64:67]
    ds_read_b64_tr_b16 v[14:15], v0 offset:49808
    v_mfma_f32_16x16x32_bf16 v[72:75], v[16:19], v[172:175], v[72:75]
    s_lshr_b32 s62, s2, 3
    s_lshl_b32 s62, s62, 2
    s_add_u32 s62, s62, s47
    s_mul_i32 s62, s62, 11008
    s_add_u32 s62, s62, 2048
    s_mov_b32 m0, 158272
    s_mov_b64 exec, 0xffff
    buffer_load_dword v6, s[24:27], s62 offen lds
    s_mov_b64 exec, -1
    s_lshl_b32 s62, s47, 17
    s_lshl_b32 s63, s50, 7
    s_add_u32 s62, s62, s63
    s_lshl_b32 s63, s47, 14
    s_add_u32 m0, s63, 77312
    s_add_u32 s62, s62, 24576
    buffer_load_dwordx4 v1, s[12:15], s62 offen lds
    s_add_u32 m0, s63, 78336
    s_add_u32 s62, s62, 8192
    buffer_load_dwordx4 v1, s[12:15], s62 offen lds
    s_add_u32 m0, s63, 79360
    s_add_u32 s62, s62, 8192
    buffer_load_dwordx4 v1, s[12:15], s62 offen lds
    ds_read_b64_tr_b16 v[16:17], v0 offset:57792
    v_mfma_f32_16x16x32_bf16 v[68:71], v[20:23], v[168:171], v[68:71]
    ds_read_b64_tr_b16 v[18:19], v0 offset:58048
    v_mfma_f32_16x16x32_bf16 v[76:79], v[20:23], v[172:175], v[76:79]
    ds_read_b64_tr_b16 v[20:21], v0 offset:57808
    s_waitcnt lgkmcnt(9)
    v_mfma_f32_16x16x32_bf16 v[80:83], v[24:27], v[168:171], v[80:83]
    ds_read_b64_tr_b16 v[22:23], v0 offset:58064
    v_mfma_f32_16x16x32_bf16 v[88:91], v[24:27], v[172:175], v[88:91]
    ds_read_b64_tr_b16 v[24:25], v0 offset:50048
    s_waitcnt lgkmcnt(9)
    v_mfma_f32_16x16x32_bf16 v[84:87], v[28:31], v[168:171], v[84:87]
    ds_read_b64_tr_b16 v[26:27], v0 offset:50304
    v_mfma_f32_16x16x32_bf16 v[92:95], v[28:31], v[172:175], v[92:95]
    ds_read_b64_tr_b16 v[28:29], v0 offset:50064
    s_waitcnt lgkmcnt(9)
    v_mfma_f32_16x16x32_bf16 v[32:35], v[8:11], v[176:179], v[32:35]
    ds_read_b64_tr_b16 v[30:31], v0 offset:50320
    v_mfma_f32_16x16x32_bf16 v[40:43], v[8:11], v[180:183], v[40:43]
    ds_read_b64_tr_b16 v[8:9], v0 offset:58304
    s_waitcnt lgkmcnt(9)
    v_mfma_f32_16x16x32_bf16 v[36:39], v[12:15], v[176:179], v[36:39]
    ds_read_b64_tr_b16 v[10:11], v0 offset:58560
    v_mfma_f32_16x16x32_bf16 v[44:47], v[12:15], v[180:183], v[44:47]
    ds_read_b64_tr_b16 v[12:13], v0 offset:58320
    s_waitcnt lgkmcnt(9)
    v_mfma_f32_16x16x32_bf16 v[48:51], v[16:19], v[176:179], v[48:51]
    ds_read_b64_tr_b16 v[14:15], v0 offset:58576
    v_mfma_f32_16x16x32_bf16 v[56:59], v[16:19], v[180:183], v[56:59]
    ds_read_b64_tr_b16 v[16:17], v0 offset:53664
    s_waitcnt lgkmcnt(9)
    v_mfma_f32_16x16x32_bf16 v[52:55], v[20:23], v[176:179], v[52:55]
    ds_read_b64_tr_b16 v[18:19], v0 offset:53920
    v_mfma_f32_16x16x32_bf16 v[60:63], v[20:23], v[180:183], v[60:63]
    ds_read_b64_tr_b16 v[20:21], v0 offset:53680
    s_waitcnt lgkmcnt(9)
    v_mfma_f32_16x16x32_bf16 v[64:67], v[24:27], v[176:179], v[64:67]
    ds_read_b64_tr_b16 v[22:23], v0 offset:53936
    v_mfma_f32_16x16x32_bf16 v[72:75], v[24:27], v[180:183], v[72:75]
    s_waitcnt vmcnt(4)
    s_mov_b64 exec, 1
    ds_add_u32 v5, v6 offset:0
    s_mov_b64 exec, -1
    s_add_u32 s58, s51, 1
    s_and_b32 s58, s58, 3
    s_add_u32 s58, s58, s48
    s_xor_b32 s58, s58, 4
    s_mul_i32 s59, s58, 176128
    s_add_u32 s59, s59, s60
    s_add_u32 s58, s59, 22016
    s_add_u32 m0, s61, 16512
    s_nop 0
    buffer_load_dwordx4 v2, s[16:19], s59 offen nt lds
    s_add_u32 m0, s61, 17536
    s_nop 0
    buffer_load_dwordx4 v2, s[16:19], s58 offen nt lds
    s_add_u32 m0, s61, 24768
    s_nop 0
    buffer_load_dwordx4 v2, s[20:23], s59 offen nt lds
    s_add_u32 m0, s61, 25792
    s_nop 0
    buffer_load_dwordx4 v2, s[20:23], s58 offen nt lds
    ds_read_b64_tr_b16 v[24:25], v0 offset:61920
    s_waitcnt lgkmcnt(10)
    v_mfma_f32_16x16x32_bf16 v[68:71], v[28:31], v[176:179], v[68:71]
    ds_read_b64_tr_b16 v[26:27], v0 offset:62176
    v_mfma_f32_16x16x32_bf16 v[76:79], v[28:31], v[180:183], v[76:79]
    ds_read_b64_tr_b16 v[28:29], v0 offset:61936
    s_waitcnt lgkmcnt(10)
    v_mfma_f32_16x16x32_bf16 v[80:83], v[8:11], v[176:179], v[80:83]
    ds_read_b64_tr_b16 v[30:31], v0 offset:62192
    v_mfma_f32_16x16x32_bf16 v[88:91], v[8:11], v[180:183], v[88:91]
    ds_read_b64_tr_b16 v[8:9], v0 offset:54176
    s_waitcnt lgkmcnt(10)
    v_mfma_f32_16x16x32_bf16 v[84:87], v[12:15], v[176:179], v[84:87]
    ds_read_b64_tr_b16 v[10:11], v0 offset:54432
    v_mfma_f32_16x16x32_bf16 v[92:95], v[12:15], v[180:183], v[92:95]
    ds_read_b64_tr_b16 v[12:13], v0 offset:54192
    s_waitcnt lgkmcnt(10)
    v_mfma_f32_16x16x32_bf16 v[32:35], v[16:19], v[184:187], v[32:35]
    ds_read_b64_tr_b16 v[14:15], v0 offset:54448
    v_mfma_f32_16x16x32_bf16 v[40:43], v[16:19], v[188:191], v[40:43]
    ds_read_b32 v7, v5 offset:0
    ds_read_b64_tr_b16 v[16:17], v0 offset:62432
    s_waitcnt lgkmcnt(11)
    v_mfma_f32_16x16x32_bf16 v[36:39], v[20:23], v[184:187], v[36:39]
    ds_read_b64_tr_b16 v[18:19], v0 offset:62688
    v_mfma_f32_16x16x32_bf16 v[44:47], v[20:23], v[188:191], v[44:47]
    ds_read_b64_tr_b16 v[20:21], v0 offset:62448
    s_waitcnt lgkmcnt(10)
    v_mfma_f32_16x16x32_bf16 v[48:51], v[24:27], v[184:187], v[48:51]
    ds_read_b64_tr_b16 v[22:23], v0 offset:62704
    v_mfma_f32_16x16x32_bf16 v[56:59], v[24:27], v[188:191], v[56:59]
    s_waitcnt lgkmcnt(4)
    v_cmp_gt_u32 vcc, 80, v7
    s_cbranch_vccz L_ldone_28
    s_mov_b32 s70, 1000000
L_lspin_27:
    ds_read_b32 v7, v5 offset:0
    s_waitcnt lgkmcnt(0)
    v_cmp_gt_u32 vcc, 80, v7
    s_cbranch_vccz L_ldone_28
    s_sub_u32 s70, s70, 1
    s_cmp_lg_u32 s70, 0
    s_cbranch_scc1 L_lspin_27
L_ldone_28:
    ds_read_b64_tr_b16 v[24:25], v0 offset:0
    v_mfma_f32_16x16x32_bf16 v[52:55], v[28:31], v[184:187], v[52:55]
    ds_read_b64_tr_b16 v[26:27], v0 offset:256
    v_mfma_f32_16x16x32_bf16 v[60:63], v[28:31], v[188:191], v[60:63]
    ds_read_b64_tr_b16 v[28:29], v0 offset:16
    v_mfma_f32_16x16x32_bf16 v[64:67], v[8:11], v[184:187], v[64:67]
    ds_read_b64_tr_b16 v[30:31], v0 offset:272
    v_mfma_f32_16x16x32_bf16 v[72:75], v[8:11], v[188:191], v[72:75]
    s_lshr_b32 s62, s2, 3
    s_lshl_b32 s62, s62, 2
    s_add_u32 s62, s62, s47
    s_mul_i32 s62, s62, 11008
    s_add_u32 s62, s62, 4096
    s_mov_b32 m0, 158272
    s_mov_b64 exec, 0xffff
    buffer_load_dword v6, s[24:27], s62 offen lds
    s_mov_b64 exec, -1
    s_lshl_b32 s62, s47, 17
    s_lshl_b32 s63, s50, 7
    s_add_u32 s62, s62, s63
    s_lshl_b32 s63, s47, 14
    s_add_u32 m0, s63, 80384
    s_add_u32 s62, s62, 49152
    buffer_load_dwordx4 v1, s[12:15], s62 offen lds
    s_add_u32 m0, s63, 81408
    s_add_u32 s62, s62, 8192
    buffer_load_dwordx4 v1, s[12:15], s62 offen lds
    s_add_u32 m0, s63, 82432
    s_add_u32 s62, s62, 8192
    buffer_load_dwordx4 v1, s[12:15], s62 offen lds
    ds_read_b64_tr_b16 v[8:9], v0 offset:8256
    v_mfma_f32_16x16x32_bf16 v[68:71], v[12:15], v[184:187], v[68:71]
    ds_read_b64_tr_b16 v[10:11], v0 offset:8512
    v_mfma_f32_16x16x32_bf16 v[76:79], v[12:15], v[188:191], v[76:79]
    ds_read_b64_tr_b16 v[12:13], v0 offset:8272
    s_waitcnt lgkmcnt(9)
    v_mfma_f32_16x16x32_bf16 v[80:83], v[16:19], v[184:187], v[80:83]
    ds_read_b64_tr_b16 v[14:15], v0 offset:8528
    v_mfma_f32_16x16x32_bf16 v[88:91], v[16:19], v[188:191], v[88:91]
    ds_read_b64_tr_b16 v[16:17], v0 offset:512
    s_waitcnt lgkmcnt(9)
    v_mfma_f32_16x16x32_bf16 v[84:87], v[20:23], v[184:187], v[84:87]
    ds_read_b64_tr_b16 v[18:19], v0 offset:768
    v_mfma_f32_16x16x32_bf16 v[92:95], v[20:23], v[188:191], v[92:95]
    ds_read_b64_tr_b16 v[20:21], v0 offset:528
    s_waitcnt lgkmcnt(9)
    v_mfma_f32_16x16x32_bf16 v[32:35], v[24:27], v[192:195], v[32:35]
    ds_read_b64_tr_b16 v[22:23], v0 offset:784
    v_mfma_f32_16x16x32_bf16 v[40:43], v[24:27], v[196:199], v[40:43]
    ds_read_b64_tr_b16 v[24:25], v0 offset:8768
    s_waitcnt lgkmcnt(9)
    v_mfma_f32_16x16x32_bf16 v[36:39], v[28:31], v[192:195], v[36:39]
    ds_read_b64_tr_b16 v[26:27], v0 offset:9024
    v_mfma_f32_16x16x32_bf16 v[44:47], v[28:31], v[196:199], v[44:47]
    ds_read_b64_tr_b16 v[28:29], v0 offset:8784
    s_waitcnt lgkmcnt(9)
    v_mfma_f32_16x16x32_bf16 v[48:51], v[8:11], v[192:195], v[48:51]
    ds_read_b64_tr_b16 v[30:31], v0 offset:9040
    v_mfma_f32_16x16x32_bf16 v[56:59], v[8:11], v[196:199], v[56:59]
    ds_read_b64_tr_b16 v[8:9], v0 offset:4128
    s_waitcnt lgkmcnt(9)
    v_mfma_f32_16x16x32_bf16 v[52:55], v[12:15], v[192:195], v[52:55]
    ds_read_b64_tr_b16 v[10:11], v0 offset:4384
    v_mfma_f32_16x16x32_bf16 v[60:63], v[12:15], v[196:199], v[60:63]
    ds_read_b64_tr_b16 v[12:13], v0 offset:4144
    s_waitcnt lgkmcnt(9)
    v_mfma_f32_16x16x32_bf16 v[64:67], v[16:19], v[192:195], v[64:67]
    ds_read_b64_tr_b16 v[14:15], v0 offset:4400
    v_mfma_f32_16x16x32_bf16 v[72:75], v[16:19], v[196:199], v[72:75]
    s_waitcnt vmcnt(4)
    s_mov_b64 exec, 1
    ds_add_u32 v5, v6 offset:0
    s_mov_b64 exec, -1
    s_add_u32 s58, s51, 2
    s_and_b32 s58, s58, 3
    s_add_u32 s58, s58, s48
    s_xor_b32 s58, s58, 4
    s_mul_i32 s59, s58, 176128
    s_add_u32 s59, s59, s60
    s_add_u32 s58, s59, 22016
    s_add_u32 m0, s61, 33024
    s_nop 0
    buffer_load_dwordx4 v2, s[16:19], s59 offen nt lds
    s_add_u32 m0, s61, 34048
    s_nop 0
    buffer_load_dwordx4 v2, s[16:19], s58 offen nt lds
    s_add_u32 m0, s61, 41280
    s_nop 0
    buffer_load_dwordx4 v2, s[20:23], s59 offen nt lds
    s_add_u32 m0, s61, 42304
    s_nop 0
    buffer_load_dwordx4 v2, s[20:23], s58 offen nt lds
    ds_read_b64_tr_b16 v[16:17], v0 offset:12384
    s_waitcnt lgkmcnt(10)
    v_mfma_f32_16x16x32_bf16 v[68:71], v[20:23], v[192:195], v[68:71]
    ds_read_b64_tr_b16 v[18:19], v0 offset:12640
    v_mfma_f32_16x16x32_bf16 v[76:79], v[20:23], v[196:199], v[76:79]
    ds_read_b64_tr_b16 v[20:21], v0 offset:12400
    s_waitcnt lgkmcnt(10)
    v_mfma_f32_16x16x32_bf16 v[80:83], v[24:27], v[192:195], v[80:83]
    ds_read_b64_tr_b16 v[22:23], v0 offset:12656
    v_mfma_f32_16x16x32_bf16 v[88:91], v[24:27], v[196:199], v[88:91]
    ds_read_b64_tr_b16 v[24:25], v0 offset:4640
    s_waitcnt lgkmcnt(10)
    v_mfma_f32_16x16x32_bf16 v[84:87], v[28:31], v[192:195], v[84:87]
    ds_read_b64_tr_b16 v[26:27], v0 offset:4896
    v_mfma_f32_16x16x32_bf16 v[92:95], v[28:31], v[196:199], v[92:95]
    ds_read_b64_tr_b16 v[28:29], v0 offset:4656
    s_waitcnt lgkmcnt(10)
    v_mfma_f32_16x16x32_bf16 v[32:35], v[8:11], v[200:203], v[32:35]
    ds_read_b64_tr_b16 v[30:31], v0 offset:4912
    v_mfma_f32_16x16x32_bf16 v[40:43], v[8:11], v[204:207], v[40:43]
    ds_read_b32 v7, v5 offset:0
    ds_read_b64_tr_b16 v[8:9], v0 offset:12896
    s_waitcnt lgkmcnt(11)
    v_mfma_f32_16x16x32_bf16 v[36:39], v[12:15], v[200:203], v[36:39]
    ds_read_b64_tr_b16 v[10:11], v0 offset:13152
    v_mfma_f32_16x16x32_bf16 v[44:47], v[12:15], v[204:207], v[44:47]
    ds_read_b64_tr_b16 v[12:13], v0 offset:12912
    s_waitcnt lgkmcnt(10)
    v_mfma_f32_16x16x32_bf16 v[48:51], v[16:19], v[200:203], v[48:51]
    ds_read_b64_tr_b16 v[14:15], v0 offset:13168
    v_mfma_f32_16x16x32_bf16 v[56:59], v[16:19], v[204:207], v[56:59]
    s_waitcnt lgkmcnt(4)
    v_cmp_gt_u32 vcc, 96, v7
    s_cbranch_vccz L_ldone_30
    s_mov_b32 s70, 1000000
L_lspin_29:
    ds_read_b32 v7, v5 offset:0
    s_waitcnt lgkmcnt(0)
    v_cmp_gt_u32 vcc, 96, v7
    s_cbranch_vccz L_ldone_30
    s_sub_u32 s70, s70, 1
    s_cmp_lg_u32 s70, 0
    s_cbranch_scc1 L_lspin_29
L_ldone_30:
    ds_read_b64_tr_b16 v[16:17], v0 offset:16512
    v_mfma_f32_16x16x32_bf16 v[52:55], v[20:23], v[200:203], v[52:55]
    ds_read_b64_tr_b16 v[18:19], v0 offset:16768
    v_mfma_f32_16x16x32_bf16 v[60:63], v[20:23], v[204:207], v[60:63]
    ds_read_b64_tr_b16 v[20:21], v0 offset:16528
    v_mfma_f32_16x16x32_bf16 v[64:67], v[24:27], v[200:203], v[64:67]
    ds_read_b64_tr_b16 v[22:23], v0 offset:16784
    v_mfma_f32_16x16x32_bf16 v[72:75], v[24:27], v[204:207], v[72:75]
    s_lshr_b32 s62, s2, 3
    s_lshl_b32 s62, s62, 2
    s_add_u32 s62, s62, s47
    s_mul_i32 s62, s62, 11008
    s_add_u32 s62, s62, 6144
    s_mov_b32 m0, 158272
    s_mov_b64 exec, 0xffff
    buffer_load_dword v6, s[24:27], s62 offen lds
    s_mov_b64 exec, -1
    s_lshl_b32 s62, s47, 17
    s_lshl_b32 s63, s50, 7
    s_add_u32 s62, s62, s63
    s_lshl_b32 s63, s47, 14
    s_add_u32 m0, s63, 83456
    s_add_u32 s62, s62, 73728
    buffer_load_dwordx4 v1, s[12:15], s62 offen lds
    s_add_u32 m0, s63, 84480
    s_add_u32 s62, s62, 8192
    buffer_load_dwordx4 v1, s[12:15], s62 offen lds
    s_add_u32 m0, s63, 85504
    s_add_u32 s62, s62, 8192
    buffer_load_dwordx4 v1, s[12:15], s62 offen lds
    ds_read_b64_tr_b16 v[24:25], v0 offset:24768
    v_mfma_f32_16x16x32_bf16 v[68:71], v[28:31], v[200:203], v[68:71]
    ds_read_b64_tr_b16 v[26:27], v0 offset:25024
    v_mfma_f32_16x16x32_bf16 v[76:79], v[28:31], v[204:207], v[76:79]
    ds_read_b64_tr_b16 v[28:29], v0 offset:24784
    s_waitcnt lgkmcnt(9)
    v_mfma_f32_16x16x32_bf16 v[80:83], v[8:11], v[200:203], v[80:83]
    ds_read_b64_tr_b16 v[30:31], v0 offset:25040
    v_mfma_f32_16x16x32_bf16 v[88:91], v[8:11], v[204:207], v[88:91]
    ds_read_b64_tr_b16 v[8:9], v0 offset:17024
    s_waitcnt lgkmcnt(9)
    v_mfma_f32_16x16x32_bf16 v[84:87], v[12:15], v[200:203], v[84:87]
    ds_read_b64_tr_b16 v[10:11], v0 offset:17280
    v_mfma_f32_16x16x32_bf16 v[92:95], v[12:15], v[204:207], v[92:95]
    ds_read_b64_tr_b16 v[12:13], v0 offset:17040
    s_waitcnt lgkmcnt(9)
    v_mfma_f32_16x16x32_bf16 v[32:35], v[16:19], v[208:211], v[32:35]
    ds_read_b64_tr_b16 v[14:15], v0 offset:17296
    v_mfma_f32_16x16x32_bf16 v[40:43], v[16:19], v[212:215], v[40:43]
    ds_read_b64_tr_b16 v[16:17], v0 offset:25280
    s_waitcnt lgkmcnt(9)
    v_mfma_f32_16x16x32_bf16 v[36:39], v[20:23], v[208:211], v[36:39]
    ds_read_b64_tr_b16 v[18:19], v0 offset:25536
    v_mfma_f32_16x16x32_bf16 v[44:47], v[20:23], v[212:215], v[44:47]
    ds_read_b64_tr_b16 v[20:21], v0 offset:25296
    s_waitcnt lgkmcnt(9)
    v_mfma_f32_16x16x32_bf16 v[48:51], v[24:27], v[208:211], v[48:51]
    ds_read_b64_tr_b16 v[22:23], v0 offset:25552
    v_mfma_f32_16x16x32_bf16 v[56:59], v[24:27], v[212:215], v[56:59]
    ds_read_b64_tr_b16 v[24:25], v0 offset:20640
    s_waitcnt lgkmcnt(9)
    v_mfma_f32_16x16x32_bf16 v[52:55], v[28:31], v[208:211], v[52:55]
    ds_read_b64_tr_b16 v[26:27], v0 offset:20896
    v_mfma_f32_16x16x32_bf16 v[60:63], v[28:31], v[212:215], v[60:63]
    ds_read_b64_tr_b16 v[28:29], v0 offset:20656
    s_waitcnt lgkmcnt(9)
    v_mfma_f32_16x16x32_bf16 v[64:67], v[8:11], v[208:211], v[64:67]
    ds_read_b64_tr_b16 v[30:31], v0 offset:20912
    v_mfma_f32_16x16x32_bf16 v[72:75], v[8:11], v[212:215], v[72:75]
    s_waitcnt vmcnt(4)
    s_mov_b64 exec, 1
    ds_add_u32 v5, v6 offset:0
    s_mov_b64 exec, -1
    s_add_u32 s58, s51, 3
    s_and_b32 s58, s58, 3
    s_add_u32 s58, s58, s48
    s_xor_b32 s58, s58, 4
    s_mul_i32 s59, s58, 176128
    s_add_u32 s59, s59, s60
    s_add_u32 s58, s59, 22016
    s_add_u32 m0, s61, 49536
    s_nop 0
    buffer_load_dwordx4 v2, s[16:19], s59 offen nt lds
    s_add_u32 m0, s61, 50560
    s_nop 0
    buffer_load_dwordx4 v2, s[16:19], s58 offen nt lds
    s_add_u32 m0, s61, 57792
    s_nop 0
    buffer_load_dwordx4 v2, s[20:23], s59 offen nt lds
    s_add_u32 m0, s61, 58816
    s_nop 0
    buffer_load_dwordx4 v2, s[20:23], s58 offen nt lds
    ds_read_b64_tr_b16 v[8:9], v0 offset:28896
    s_waitcnt lgkmcnt(10)
    v_mfma_f32_16x16x32_bf16 v[68:71], v[12:15], v[208:211], v[68:71]
    ds_read_b64_tr_b16 v[10:11], v0 offset:29152
    v_mfma_f32_16x16x32_bf16 v[76:79], v[12:15], v[212:215], v[76:79]
    ds_read_b64_tr_b16 v[12:13], v0 offset:28912
    s_waitcnt lgkmcnt(10)
    v_mfma_f32_16x16x32_bf16 v[80:83], v[16:19], v[208:211], v[80:83]
    ds_read_b64_tr_b16 v[14:15], v0 offset:29168
    v_mfma_f32_16x16x32_bf16 v[88:91], v[16:19], v[212:215], v[88:91]
    ds_read_b64_tr_b16 v[16:17], v0 offset:21152
    s_waitcnt lgkmcnt(10)
    v_mfma_f32_16x16x32_bf16 v[84:87], v[20:23], v[208:211], v[84:87]
    ds_read_b64_tr_b16 v[18:19], v0 offset:21408
    v_mfma_f32_16x16x32_bf16 v[92:95], v[20:23], v[212:215], v[92:95]
    ds_read_b64_tr_b16 v[20:21], v0 offset:21168
    s_waitcnt lgkmcnt(10)
    v_mfma_f32_16x16x32_bf16 v[32:35], v[24:27], v[216:219], v[32:35]
    ds_read_b64_tr_b16 v[22:23], v0 offset:21424
    v_mfma_f32_16x16x32_bf16 v[40:43], v[24:27], v[220:223], v[40:43]
    ds_read_b32 v7, v5 offset:0
    ds_read_b64_tr_b16 v[24:25], v0 offset:29408
    s_waitcnt lgkmcnt(11)
    v_mfma_f32_16x16x32_bf16 v[36:39], v[28:31], v[216:219], v[36:39]
    ds_read_b64_tr_b16 v[26:27], v0 offset:29664
    v_mfma_f32_16x16x32_bf16 v[44:47], v[28:31], v[220:223], v[44:47]
    ds_read_b64_tr_b16 v[28:29], v0 offset:29424
    s_waitcnt lgkmcnt(10)
    v_mfma_f32_16x16x32_bf16 v[48:51], v[8:11], v[216:219], v[48:51]
    ds_read_b64_tr_b16 v[30:31], v0 offset:29680
    v_mfma_f32_16x16x32_bf16 v[56:59], v[8:11], v[220:223], v[56:59]
    s_waitcnt lgkmcnt(4)
    v_cmp_gt_u32 vcc, 112, v7
    s_cbranch_vccz L_ldone_32
    s_mov_b32 s70, 1000000
L_lspin_31:
    ds_read_b32 v7, v5 offset:0
    s_waitcnt lgkmcnt(0)
    v_cmp_gt_u32 vcc, 112, v7
    s_cbranch_vccz L_ldone_32
    s_sub_u32 s70, s70, 1
    s_cmp_lg_u32 s70, 0
    s_cbranch_scc1 L_lspin_31
L_ldone_32:
    ds_read_b64_tr_b16 v[8:9], v0 offset:33024
    v_mfma_f32_16x16x32_bf16 v[52:55], v[12:15], v[216:219], v[52:55]
    ds_read_b64_tr_b16 v[10:11], v0 offset:33280
    v_mfma_f32_16x16x32_bf16 v[60:63], v[12:15], v[220:223], v[60:63]
    ds_read_b64_tr_b16 v[12:13], v0 offset:33040
    v_mfma_f32_16x16x32_bf16 v[64:67], v[16:19], v[216:219], v[64:67]
    ds_read_b64_tr_b16 v[14:15], v0 offset:33296
    v_mfma_f32_16x16x32_bf16 v[72:75], v[16:19], v[220:223], v[72:75]
    s_lshr_b32 s62, s2, 3
    s_lshl_b32 s62, s62, 2
    s_add_u32 s62, s62, s47
    s_mul_i32 s62, s62, 11008
    s_add_u32 s62, s62, 8192
    s_mov_b32 m0, 158272
    s_mov_b64 exec, 0xffff
    buffer_load_dword v6, s[24:27], s62 offen lds
    s_mov_b64 exec, -1
    s_lshl_b32 s62, s47, 17
    s_lshl_b32 s63, s50, 7
    s_add_u32 s62, s62, s63
    s_lshl_b32 s63, s47, 14
    s_add_u32 m0, s63, 86528
    s_add_u32 s62, s62, 98304
    buffer_load_dwordx4 v1, s[12:15], s62 offen lds
    s_add_u32 m0, s63, 87552
    s_add_u32 s62, s62, 8192
    buffer_load_dwordx4 v1, s[12:15], s62 offen lds
    ds_read_b64_tr_b16 v[16:17], v0 offset:41280
    v_mfma_f32_16x16x32_bf16 v[68:71], v[20:23], v[216:219], v[68:71]
    ds_read_b64_tr_b16 v[18:19], v0 offset:41536
    v_mfma_f32_16x16x32_bf16 v[76:79], v[20:23], v[220:223], v[76:79]
    ds_read_b64_tr_b16 v[20:21], v0 offset:41296
    s_waitcnt lgkmcnt(9)
    v_mfma_f32_16x16x32_bf16 v[80:83], v[24:27], v[216:219], v[80:83]
    ds_read_b64_tr_b16 v[22:23], v0 offset:41552
    v_mfma_f32_16x16x32_bf16 v[88:91], v[24:27], v[220:223], v[88:91]
    ds_read_b64_tr_b16 v[24:25], v0 offset:33536
    s_waitcnt lgkmcnt(9)
    v_mfma_f32_16x16x32_bf16 v[84:87], v[28:31], v[216:219], v[84:87]
    ds_read_b64_tr_b16 v[26:27], v0 offset:33792
    v_mfma_f32_16x16x32_bf16 v[92:95], v[28:31], v[220:223], v[92:95]
    ds_read_b64_tr_b16 v[28:29], v0 offset:33552
    s_waitcnt lgkmcnt(9)
    v_mfma_f32_16x16x32_bf16 v[32:35], v[8:11], v[224:227], v[32:35]
    ds_read_b64_tr_b16 v[30:31], v0 offset:33808
    v_mfma_f32_16x16x32_bf16 v[40:43], v[8:11], v[228:231], v[40:43]
    ds_read_b64_tr_b16 v[8:9], v0 offset:41792
    s_waitcnt lgkmcnt(9)
    v_mfma_f32_16x16x32_bf16 v[36:39], v[12:15], v[224:227], v[36:39]
    ds_read_b64_tr_b16 v[10:11], v0 offset:42048
    v_mfma_f32_16x16x32_bf16 v[44:47], v[12:15], v[228:231], v[44:47]
    ds_read_b64_tr_b16 v[12:13], v0 offset:41808
    s_waitcnt lgkmcnt(9)
    v_mfma_f32_16x16x32_bf16 v[48:51], v[16:19], v[224:227], v[48:51]
    ds_read_b64_tr_b16 v[14:15], v0 offset:42064
    v_mfma_f32_16x16x32_bf16 v[56:59], v[16:19], v[228:231], v[56:59]
    ds_read_b64_tr_b16 v[16:17], v0 offset:37152
    s_waitcnt lgkmcnt(9)
    v_mfma_f32_16x16x32_bf16 v[52:55], v[20:23], v[224:227], v[52:55]
    ds_read_b64_tr_b16 v[18:19], v0 offset:37408
    v_mfma_f32_16x16x32_bf16 v[60:63], v[20:23], v[228:231], v[60:63]
    ds_read_b64_tr_b16 v[20:21], v0 offset:37168
    s_waitcnt lgkmcnt(9)
    v_mfma_f32_16x16x32_bf16 v[64:67], v[24:27], v[224:227], v[64:67]
    ds_read_b64_tr_b16 v[22:23], v0 offset:37424
    v_mfma_f32_16x16x32_bf16 v[72:75], v[24:27], v[228:231], v[72:75]
    s_waitcnt vmcnt(3)
    s_mov_b64 exec, 1
    ds_add_u32 v5, v6 offset:0
    s_mov_b64 exec, -1
    ds_read_b64_tr_b16 v[24:25], v0 offset:45408
    s_waitcnt lgkmcnt(10)
    v_mfma_f32_16x16x32_bf16 v[68:71], v[28:31], v[224:227], v[68:71]
    ds_read_b64_tr_b16 v[26:27], v0 offset:45664
    v_mfma_f32_16x16x32_bf16 v[76:79], v[28:31], v[228:231], v[76:79]
    ds_read_b64_tr_b16 v[28:29], v0 offset:45424
    s_waitcnt lgkmcnt(10)
    v_mfma_f32_16x16x32_bf16 v[80:83], v[8:11], v[224:227], v[80:83]
    ds_read_b64_tr_b16 v[30:31], v0 offset:45680
    v_mfma_f32_16x16x32_bf16 v[88:91], v[8:11], v[228:231], v[88:91]
    ds_read_b64_tr_b16 v[8:9], v0 offset:37664
    s_waitcnt lgkmcnt(10)
    v_mfma_f32_16x16x32_bf16 v[84:87], v[12:15], v[224:227], v[84:87]
    ds_read_b64_tr_b16 v[10:11], v0 offset:37920
    v_mfma_f32_16x16x32_bf16 v[92:95], v[12:15], v[228:231], v[92:95]
    ds_read_b64_tr_b16 v[12:13], v0 offset:37680
    s_waitcnt lgkmcnt(10)
    v_mfma_f32_16x16x32_bf16 v[32:35], v[16:19], v[232:235], v[32:35]
    ds_read_b64_tr_b16 v[14:15], v0 offset:37936
    v_mfma_f32_16x16x32_bf16 v[40:43], v[16:19], v[236:239], v[40:43]
    ds_read_b32 v7, v5 offset:0
    ds_read_b64_tr_b16 v[16:17], v0 offset:45920
    s_waitcnt lgkmcnt(11)
    v_mfma_f32_16x16x32_bf16 v[36:39], v[20:23], v[232:235], v[36:39]
    ds_read_b64_tr_b16 v[18:19], v0 offset:46176
    v_mfma_f32_16x16x32_bf16 v[44:47], v[20:23], v[236:239], v[44:47]
    ds_read_b64_tr_b16 v[20:21], v0 offset:45936
    s_waitcnt lgkmcnt(10)
    v_mfma_f32_16x16x32_bf16 v[48:51], v[24:27], v[232:235], v[48:51]
    ds_read_b64_tr_b16 v[22:23], v0 offset:46192
    v_mfma_f32_16x16x32_bf16 v[56:59], v[24:27], v[236:239], v[56:59]
    s_waitcnt lgkmcnt(4)
    v_cmp_gt_u32 vcc, 128, v7
    s_cbranch_vccz L_ldone_34
    s_mov_b32 s70, 1000000
L_lspin_33:
    ds_read_b32 v7, v5 offset:0
    s_waitcnt lgkmcnt(0)
    v_cmp_gt_u32 vcc, 128, v7
    s_cbranch_vccz L_ldone_34
    s_sub_u32 s70, s70, 1
    s_cmp_lg_u32 s70, 0
    s_cbranch_scc1 L_lspin_33
L_ldone_34:
    ds_read_b64_tr_b16 v[24:25], v0 offset:49536
    v_mfma_f32_16x16x32_bf16 v[52:55], v[28:31], v[232:235], v[52:55]
    ds_read_b64_tr_b16 v[26:27], v0 offset:49792
    v_mfma_f32_16x16x32_bf16 v[60:63], v[28:31], v[236:239], v[60:63]
    s_cmp_eq_u32 s47, 0
    s_cbranch_scc1 L_tk0
L_tk_back0:
    ds_read_b64_tr_b16 v[28:29], v0 offset:49552
    v_mfma_f32_16x16x32_bf16 v[64:67], v[8:11], v[232:235], v[64:67]
    ds_read_b64_tr_b16 v[30:31], v0 offset:49808
    v_mfma_f32_16x16x32_bf16 v[72:75], v[8:11], v[236:239], v[72:75]
    s_lshr_b32 s62, s2, 3
    s_lshl_b32 s62, s62, 2
    s_add_u32 s62, s62, s47
    s_mul_i32 s62, s62, 11008
    s_add_u32 s62, s62, 10240
    s_mov_b32 m0, 158272
    s_mov_b64 exec, 0x3f
    buffer_load_dword v6, s[24:27], s62 offen lds
    s_mov_b64 exec, -1
    s_lshl_b32 s62, s47, 17
    s_lshl_b32 s63, s50, 7
    s_add_u32 s62, s62, s63
    s_lshl_b32 s63, s47, 14
    s_add_u32 m0, s63, 88576
    s_add_u32 s62, s62, 114688
    buffer_load_dwordx4 v1, s[12:15], s62 offen lds
    s_add_u32 m0, s63, 89600
    s_add_u32 s62, s62, 8192
    buffer_load_dwordx4 v1, s[12:15], s62 offen lds
    ds_read_b64_tr_b16 v[8:9], v0 offset:57792
    v_mfma_f32_16x16x32_bf16 v[68:71], v[12:15], v[232:235], v[68:71]
    ds_read_b64_tr_b16 v[10:11], v0 offset:58048
    v_mfma_f32_16x16x32_bf16 v[76:79], v[12:15], v[236:239], v[76:79]
    ds_read_b64_tr_b16 v[12:13], v0 offset:57808
    s_waitcnt lgkmcnt(9)
    v_mfma_f32_16x16x32_bf16 v[80:83], v[16:19], v[232:235], v[80:83]
    ds_read_b64_tr_b16 v[14:15], v0 offset:58064
    v_mfma_f32_16x16x32_bf16 v[88:91], v[16:19], v[236:239], v[88:91]
    ds_read_b64_tr_b16 v[16:17], v0 offset:50048
    s_waitcnt lgkmcnt(9)
    v_mfma_f32_16x16x32_bf16 v[84:87], v[20:23], v[232:235], v[84:87]
    ds_read_b64_tr_b16 v[18:19], v0 offset:50304
    v_mfma_f32_16x16x32_bf16 v[92:95], v[20:23], v[236:239], v[92:95]
    ds_read_b64_tr_b16 v[20:21], v0 offset:50064
    s_waitcnt lgkmcnt(9)
    v_mfma_f32_16x16x32_bf16 v[32:35], v[24:27], v[240:243], v[32:35]
    ds_read_b64_tr_b16 v[22:23], v0 offset:50320
    v_mfma_f32_16x16x32_bf16 v[40:43], v[24:27], v[244:247], v[40:43]
    ds_read_b64_tr_b16 v[24:25], v0 offset:58304
    s_waitcnt lgkmcnt(9)
    v_mfma_f32_16x16x32_bf16 v[36:39], v[28:31], v[240:243], v[36:39]
    ds_read_b64_tr_b16 v[26:27], v0 offset:58560
    v_mfma_f32_16x16x32_bf16 v[44:47], v[28:31], v[244:247], v[44:47]
    s_cmp_eq_u32 s47, 0
    s_cbranch_scc1 L_tk1
L_tk_back1:
    ds_read_b64_tr_b16 v[28:29], v0 offset:58320
    s_waitcnt lgkmcnt(9)
    v_mfma_f32_16x16x32_bf16 v[48:51], v[8:11], v[240:243], v[48:51]
    ds_read_b64_tr_b16 v[30:31], v0 offset:58576
    v_mfma_f32_16x16x32_bf16 v[56:59], v[8:11], v[244:247], v[56:59]
    ds_read_b64_tr_b16 v[8:9], v0 offset:53664
    s_waitcnt lgkmcnt(9)
    v_mfma_f32_16x16x32_bf16 v[52:55], v[12:15], v[240:243], v[52:55]
    ds_read_b64_tr_b16 v[10:11], v0 offset:53920
    v_mfma_f32_16x16x32_bf16 v[60:63], v[12:15], v[244:247], v[60:63]
    ds_read_b64_tr_b16 v[12:13], v0 offset:53680
    s_waitcnt lgkmcnt(9)
    v_mfma_f32_16x16x32_bf16 v[64:67], v[16:19], v[240:243], v[64:67]
    ds_read_b64_tr_b16 v[14:15], v0 offset:53936
    v_mfma_f32_16x16x32_bf16 v[72:75], v[16:19], v[244:247], v[72:75]
    ds_read_b32 v7, v5 offset:56
    ds_read_b64_tr_b16 v[16:17], v0 offset:61920
    s_waitcnt lgkmcnt(10)
    v_mfma_f32_16x16x32_bf16 v[68:71], v[20:23], v[240:243], v[68:71]
    ds_read_b64_tr_b16 v[18:19], v0 offset:62176
    v_mfma_f32_16x16x32_bf16 v[76:79], v[20:23], v[244:247], v[76:79]
    ds_read_b64_tr_b16 v[20:21], v0 offset:61936
    s_waitcnt lgkmcnt(10)
    v_mfma_f32_16x16x32_bf16 v[80:83], v[24:27], v[240:243], v[80:83]
    ds_read_b64_tr_b16 v[22:23], v0 offset:62192
    v_mfma_f32_16x16x32_bf16 v[88:91], v[24:27], v[244:247], v[88:91]
    s_waitcnt lgkmcnt(4)
    v_cmp_gt_u32 vcc, 1, v7
    s_cbranch_vccz L_ldone_36
    s_mov_b32 s70, 1000000
L_lspin_35:
    ds_read_b32 v7, v5 offset:56
    s_waitcnt lgkmcnt(0)
    v_cmp_gt_u32 vcc, 1, v7
    s_cbranch_vccz L_ldone_36
    s_sub_u32 s70, s70, 1
    s_cmp_lg_u32 s70, 0
    s_cbranch_scc1 L_lspin_35
L_ldone_36:
    v_readfirstlane_b32 s53, v7
    s_sub_u32 s53, s53, 1
    s_lshl_b32 s60, s53, 6
    s_add_u32 s60, s60, 2048
    s_cmp_lt_u32 s53, 11
    s_cselect_b32 s60, s60, 536870912
    s_add_u32 s58, s51, 0
    s_and_b32 s58, s58, 3
    s_add_u32 s58, s58, s48
    s_and_b32 s58, s58, 3
    s_mul_i32 s59, s58, 176128
    s_add_u32 s59, s59, s60
    s_add_u32 s58, s59, 22016
    s_add_u32 m0, s61, 0
    s_nop 0
    buffer_load_dwordx4 v3, s[16:19], s59 offen  lds
    s_add_u32 m0, s61, 1024
    s_nop 0
    buffer_load_dwordx4 v3, s[16:19], s58 offen  lds
    s_add_u32 m0, s61, 8256
    s_nop 0
    buffer_load_dwordx4 v3, s[20:23], s59 offen  lds
    s_add_u32 m0, s61, 9280
    s_nop 0
    buffer_load_dwordx4 v3, s[20:23], s58 offen  lds
    ds_read_b64_tr_b16 v[24:25], v0 offset:54176
    v_mfma_f32_16x16x32_bf16 v[84:87], v[28:31], v[240:243], v[84:87]
    ds_read_b64_tr_b16 v[26:27], v0 offset:54432
    v_mfma_f32_16x16x32_bf16 v[92:95], v[28:31], v[244:247], v[92:95]
    ds_read_b64_tr_b16 v[28:29], v0 offset:54192
    v_mfma_f32_16x16x32_bf16 v[32:35], v[8:11], v[248:251], v[32:35]
    ds_read_b64_tr_b16 v[30:31], v0 offset:54448
    v_mfma_f32_16x16x32_bf16 v[40:43], v[8:11], v[252:255], v[40:43]
    ds_read_b64_tr_b16 v[8:9], v0 offset:62432
    v_mfma_f32_16x16x32_bf16 v[36:39], v[12:15], v[248:251], v[36:39]
    ds_read_b64_tr_b16 v[10:11], v0 offset:62688
    v_mfma_f32_16x16x32_bf16 v[44:47], v[12:15], v[252:255], v[44:47]
    ds_read_b64_tr_b16 v[12:13], v0 offset:62448
    s_waitcnt lgkmcnt(9)
    v_mfma_f32_16x16x32_bf16 v[48:51], v[16:19], v[248:251], v[48:51]
    ds_read_b64_tr_b16 v[14:15], v0 offset:62704
    v_mfma_f32_16x16x32_bf16 v[56:59], v[16:19], v[252:255], v[56:59]
    s_waitcnt lgkmcnt(8)
    v_mfma_f32_16x16x32_bf16 v[52:55], v[20:23], v[248:251], v[52:55]
    v_mfma_f32_16x16x32_bf16 v[60:63], v[20:23], v[252:255], v[60:63]
    s_waitcnt lgkmcnt(6)
    v_mfma_f32_16x16x32_bf16 v[64:67], v[24:27], v[248:251], v[64:67]
    v_mfma_f32_16x16x32_bf16 v[72:75], v[24:27], v[252:255], v[72:75]
    s_waitcnt lgkmcnt(4)
    v_mfma_f32_16x16x32_bf16 v[68:71], v[28:31], v[248:251], v[68:71]
    v_mfma_f32_16x16x32_bf16 v[76:79], v[28:31], v[252:255], v[76:79]
    s_waitcnt lgkmcnt(2)
    v_mfma_f32_16x16x32_bf16 v[80:83], v[8:11], v[248:251], v[80:83]
    v_mfma_f32_16x16x32_bf16 v[88:91], v[8:11], v[252:255], v[88:91]
    s_waitcnt lgkmcnt(0)
    v_mfma_f32_16x16x32_bf16 v[84:87], v[12:15], v[248:251], v[84:87]
    v_mfma_f32_16x16x32_bf16 v[92:95], v[12:15], v[252:255], v[92:95]
    s_add_u32 s58, s51, 1
    s_and_b32 s58, s58, 3
    s_add_u32 s58, s58, s48
    s_and_b32 s58, s58, 3
    s_mul_i32 s59, s58, 176128
    s_add_u32 s59, s59, s60
    s_add_u32 s58, s59, 22016
    s_add_u32 m0, s61, 16512
    s_nop 0
    buffer_load_dwordx4 v3, s[16:19], s59 offen  lds
    s_add_u32 m0, s61, 17536
    s_nop 0
    buffer_load_dwordx4 v3, s[16:19], s58 offen  lds
    s_add_u32 m0, s61, 24768
    s_nop 0
    buffer_load_dwordx4 v3, s[20:23], s59 offen  lds
    s_add_u32 m0, s61, 25792
    s_nop 0
    buffer_load_dwordx4 v3, s[20:23], s58 offen  lds
    s_setprio 3
    s_lshl_b32 s66, s45, 2
    s_add_u32 s66, s66, s47
    s_mul_i32 s66, s66, 86
    s_lshl_b32 s67, s44, 2
    s_add_u32 s66, s66, s67
    s_lshl_b32 s66, s66, 10
    s_add_u32 s66, s66, 6291456
    v_add_u32 v2, 7168, v1
.p2align 3
    v_mov_b32 v8, 0xc0135761
    v_mov_b32 v9, 0xc0135761
    v_mov_b32 v10, 0xbdd2d3e8
    v_mov_b32 v11, 0xbdd2d3e8
    v_mul_f32 v96, v32, v32
    v_mul_f32 v97, v33, v33
    v_mul_f32 v98, v34, v34
    v_mul_f32 v99, v35, v35
    v_mul_f32 v100, v36, v36
    v_mul_f32 v101, v37, v37
    v_mul_f32 v102, v38, v38
    v_mul_f32 v103, v39, v39
    v_mul_f32 v104, v40, v40
    v_mul_f32 v105, v41, v41
    v_mul_f32 v106, v42, v42
    v_mul_f32 v107, v43, v43
    v_mul_f32 v108, v44, v44
    v_mul_f32 v109, v45, v45
    v_mul_f32 v110, v46, v46
    v_mul_f32 v111, v47, v47
    v_pk_fma_f32 v[96:97], v[96:97], v[10:11], v[8:9]
    v_pk_fma_f32 v[98:99], v[98:99], v[10:11], v[8:9]
    v_pk_fma_f32 v[100:101], v[100:101], v[10:11], v[8:9]
    v_pk_fma_f32 v[102:103], v[102:103], v[10:11], v[8:9]
    v_pk_fma_f32 v[104:105], v[104:105], v[10:11], v[8:9]
    v_pk_fma_f32 v[106:107], v[106:107], v[10:11], v[8:9]
    v_pk_fma_f32 v[108:109], v[108:109], v[10:11], v[8:9]
    v_pk_fma_f32 v[110:111], v[110:111], v[10:11], v[8:9]
    v_pk_mul_f32 v[96:97], v[96:97], v[32:33]
    v_pk_mul_f32 v[98:99], v[98:99], v[34:35]
    v_pk_mul_f32 v[100:101], v[100:101], v[36:37]
    v_pk_mul_f32 v[102:103], v[102:103], v[38:39]
    v_pk_mul_f32 v[104:105], v[104:105], v[40:41]
    v_pk_mul_f32 v[106:107], v[106:107], v[42:43]
    v_pk_mul_f32 v[108:109], v[108:109], v[44:45]
    v_pk_mul_f32 v[110:111], v[110:111], v[46:47]
.p2align 3
    v_exp_f32 v96, v96
    v_exp_f32 v97, v97
    v_exp_f32 v98, v98
    v_exp_f32 v99, v99
    v_exp_f32 v100, v100
    v_exp_f32 v101, v101
    v_exp_f32 v102, v102
    v_exp_f32 v103, v103
    v_exp_f32 v104, v104
    v_exp_f32 v105, v105
    v_exp_f32 v106, v106
    v_exp_f32 v107, v107
    v_exp_f32 v108, v108
    v_exp_f32 v109, v109
    v_exp_f32 v110, v110
    v_exp_f32 v111, v111
    v_pk_mul_f32 v[32:33], v[32:33], v[48:49]
    v_pk_mul_f32 v[34:35], v[34:35], v[50:51]
    v_pk_mul_f32 v[36:37], v[36:37], v[52:53]
    v_pk_mul_f32 v[38:39], v[38:39], v[54:55]
    v_pk_mul_f32 v[40:41], v[40:41], v[56:57]
    v_pk_mul_f32 v[42:43], v[42:43], v[58:59]
    v_pk_mul_f32 v[44:45], v[44:45], v[60:61]
    v_pk_mul_f32 v[46:47], v[46:47], v[62:63]
    v_pk_add_f32 v[96:97], v[96:97], 1.0 op_sel_hi:[1,0]
    v_pk_add_f32 v[98:99], v[98:99], 1.0 op_sel_hi:[1,0]
    v_pk_add_f32 v[100:101], v[100:101], 1.0 op_sel_hi:[1,0]
    v_pk_add_f32 v[102:103], v[102:103], 1.0 op_sel_hi:[1,0]
    v_pk_add_f32 v[104:105], v[104:105], 1.0 op_sel_hi:[1,0]
    v_pk_add_f32 v[106:107], v[106:107], 1.0 op_sel_hi:[1,0]
    v_pk_add_f32 v[108:109], v[108:109], 1.0 op_sel_hi:[1,0]
    v_pk_add_f32 v[110:111], v[110:111], 1.0 op_sel_hi:[1,0]
.p2align 3
    v_rcp_f32 v96, v96
    v_rcp_f32 v97, v97
    v_rcp_f32 v98, v98
    v_rcp_f32 v99, v99
    v_rcp_f32 v100, v100
    v_rcp_f32 v101, v101
    v_rcp_f32 v102, v102
    v_rcp_f32 v103, v103
    v_rcp_f32 v104, v104
    v_rcp_f32 v105, v105
    v_rcp_f32 v106, v106
    v_rcp_f32 v107, v107
    v_rcp_f32 v108, v108
    v_rcp_f32 v109, v109
    v_rcp_f32 v110, v110
    v_rcp_f32 v111, v111
    v_pk_mul_f32 v[32:33], v[32:33], v[96:97]
    v_pk_mul_f32 v[34:35], v[34:35], v[98:99]
    v_pk_mul_f32 v[36:37], v[36:37], v[100:101]
    v_pk_mul_f32 v[38:39], v[38:39], v[102:103]
    v_pk_mul_f32 v[40:41], v[40:41], v[104:105]
    v_pk_mul_f32 v[42:43], v[42:43], v[106:107]
    v_pk_mul_f32 v[44:45], v[44:45], v[108:109]
    v_pk_mul_f32 v[46:47], v[46:47], v[110:111]
    v_cvt_pk_bf16_f32 v112, v32, v33
    v_cvt_pk_bf16_f32 v113, v34, v35
    v_cvt_pk_bf16_f32 v114, v36, v37
    v_cvt_pk_bf16_f32 v115, v38, v39
    v_cvt_pk_bf16_f32 v116, v40, v41
    v_cvt_pk_bf16_f32 v117, v42, v43
    v_cvt_pk_bf16_f32 v118, v44, v45
    v_cvt_pk_bf16_f32 v119, v46, v47
    v_pk_mul_f32 v[96:97], v[64:65], v[64:65]
    v_pk_mul_f32 v[98:99], v[66:67], v[66:67]
    v_pk_mul_f32 v[100:101], v[68:69], v[68:69]
    v_pk_mul_f32 v[102:103], v[70:71], v[70:71]
    v_pk_mul_f32 v[104:105], v[72:73], v[72:73]
    v_pk_mul_f32 v[106:107], v[74:75], v[74:75]
    v_pk_mul_f32 v[108:109], v[76:77], v[76:77]
    v_pk_mul_f32 v[110:111], v[78:79], v[78:79]
    v_pk_fma_f32 v[96:97], v[96:97], v[10:11], v[8:9]
    v_pk_fma_f32 v[98:99], v[98:99], v[10:11], v[8:9]
    v_pk_fma_f32 v[100:101], v[100:101], v[10:11], v[8:9]
    v_pk_fma_f32 v[102:103], v[102:103], v[10:11], v[8:9]
    v_pk_fma_f32 v[104:105], v[104:105], v[10:11], v[8:9]
    v_pk_fma_f32 v[106:107], v[106:107], v[10:11], v[8:9]
    v_pk_fma_f32 v[108:109], v[108:109], v[10:11], v[8:9]
    v_pk_fma_f32 v[110:111], v[110:111], v[10:11], v[8:9]
    v_pk_mul_f32 v[96:97], v[96:97], v[64:65]
    v_pk_mul_f32 v[98:99], v[98:99], v[66:67]
    v_pk_mul_f32 v[100:101], v[100:101], v[68:69]
    v_pk_mul_f32 v[102:103], v[102:103], v[70:71]
    v_pk_mul_f32 v[104:105], v[104:105], v[72:73]
    v_pk_mul_f32 v[106:107], v[106:107], v[74:75]
    v_pk_mul_f32 v[108:109], v[108:109], v[76:77]
    v_pk_mul_f32 v[110:111], v[110:111], v[78:79]
    buffer_store_dwordx4 v[112:115], v4, s[40:43], s66 offen offset:0 sc1
    buffer_store_dwordx4 v[116:119], v4, s[40:43], s66 offen offset:256 sc1
.p2align 3
    v_exp_f32 v96, v96
    v_exp_f32 v97, v97
    v_exp_f32 v98, v98
    v_exp_f32 v99, v99
    v_exp_f32 v100, v100
    v_exp_f32 v101, v101
    v_exp_f32 v102, v102
    v_exp_f32 v103, v103
    v_exp_f32 v104, v104
    v_exp_f32 v105, v105
    v_exp_f32 v106, v106
    v_exp_f32 v107, v107
    v_exp_f32 v108, v108
    v_exp_f32 v109, v109
    v_exp_f32 v110, v110
    v_exp_f32 v111, v111
    v_pk_mul_f32 v[64:65], v[64:65], v[80:81]
    v_pk_mul_f32 v[66:67], v[66:67], v[82:83]
    v_pk_mul_f32 v[68:69], v[68:69], v[84:85]
    v_pk_mul_f32 v[70:71], v[70:71], v[86:87]
    v_pk_mul_f32 v[72:73], v[72:73], v[88:89]
    v_pk_mul_f32 v[74:75], v[74:75], v[90:91]
    v_pk_mul_f32 v[76:77], v[76:77], v[92:93]
    v_pk_mul_f32 v[78:79], v[78:79], v[94:95]
    v_pk_add_f32 v[96:97], v[96:97], 1.0 op_sel_hi:[1,0]
    v_pk_add_f32 v[98:99], v[98:99], 1.0 op_sel_hi:[1,0]
    v_pk_add_f32 v[100:101], v[100:101], 1.0 op_sel_hi:[1,0]
    v_pk_add_f32 v[102:103], v[102:103], 1.0 op_sel_hi:[1,0]
    v_pk_add_f32 v[104:105], v[104:105], 1.0 op_sel_hi:[1,0]
    v_pk_add_f32 v[106:107], v[106:107], 1.0 op_sel_hi:[1,0]
    v_pk_add_f32 v[108:109], v[108:109], 1.0 op_sel_hi:[1,0]
    v_pk_add_f32 v[110:111], v[110:111], 1.0 op_sel_hi:[1,0]
.p2align 3
    v_rcp_f32 v96, v96
    v_rcp_f32 v97, v97
    v_rcp_f32 v98, v98
    v_rcp_f32 v99, v99
    v_rcp_f32 v100, v100
    v_rcp_f32 v101, v101
    v_rcp_f32 v102, v102
    v_rcp_f32 v103, v103
    v_rcp_f32 v104, v104
    v_rcp_f32 v105, v105
    v_rcp_f32 v106, v106
    v_rcp_f32 v107, v107
    v_rcp_f32 v108, v108
    v_rcp_f32 v109, v109
    v_rcp_f32 v110, v110
    v_rcp_f32 v111, v111
    v_pk_mul_f32 v[64:65], v[64:65], v[96:97]
    v_pk_mul_f32 v[66:67], v[66:67], v[98:99]
    v_pk_mul_f32 v[68:69], v[68:69], v[100:101]
    v_pk_mul_f32 v[70:71], v[70:71], v[102:103]
    v_pk_mul_f32 v[72:73], v[72:73], v[104:105]
    v_pk_mul_f32 v[74:75], v[74:75], v[106:107]
    v_pk_mul_f32 v[76:77], v[76:77], v[108:109]
    v_pk_mul_f32 v[78:79], v[78:79], v[110:111]
    v_cvt_pk_bf16_f32 v120, v64, v65
    v_cvt_pk_bf16_f32 v121, v66, v67
    v_cvt_pk_bf16_f32 v122, v68, v69
    v_cvt_pk_bf16_f32 v123, v70, v71
    v_cvt_pk_bf16_f32 v124, v72, v73
    v_cvt_pk_bf16_f32 v125, v74, v75
    v_cvt_pk_bf16_f32 v126, v76, v77
    v_cvt_pk_bf16_f32 v127, v78, v79
    buffer_store_dwordx4 v[120:123], v4, s[40:43], s66 offen offset:2048 sc1
    buffer_store_dwordx4 v[124:127], v4, s[40:43], s66 offen offset:2304 sc1
    s_waitcnt vmcnt(4)
    s_mov_b64 exec, 1
    ds_add_u32 v5, v6 offset:0
    s_mov_b64 exec, -1
    ds_read_b32 v7, v5 offset:0
    s_waitcnt lgkmcnt(0)
    v_cmp_gt_u32 vcc, 144, v7
    s_cbranch_vccz L_ldone_38
    s_mov_b32 s70, 1000000
L_lspin_37:
    ds_read_b32 v7, v5 offset:0
    s_waitcnt lgkmcnt(0)
    v_cmp_gt_u32 vcc, 144, v7
    s_cbranch_vccz L_ldone_38
    s_sub_u32 s70, s70, 1
    s_cmp_lg_u32 s70, 0
    s_cbranch_scc1 L_lspin_37
L_ldone_38:
    s_setprio 0
    s_cmp_ge_u32 s53, 11
    s_cbranch_scc1 L_skipper
    s_add_u32 s58, s51, 2
    s_and_b32 s58, s58, 3
    s_add_u32 s58, s58, s48
    s_and_b32 s58, s58, 3
    s_mul_i32 s59, s58, 176128
    s_add_u32 s59, s59, s60
    s_add_u32 s58, s59, 22016
    s_add_u32 m0, s61, 33024
    s_nop 0
    buffer_load_dwordx4 v3, s[16:19], s59 offen  lds
    s_add_u32 m0, s61, 34048
    s_nop 0
    buffer_load_dwordx4 v3, s[16:19], s58 offen  lds
    s_add_u32 m0, s61, 41280
    s_nop 0
    buffer_load_dwordx4 v3, s[20:23], s59 offen  lds
    s_add_u32 m0, s61, 42304
    s_nop 0
    buffer_load_dwordx4 v3, s[20:23], s58 offen  lds
    ds_read_b64_tr_b16 v[8:9], v0 offset:0
    ds_read_b64_tr_b16 v[10:11], v0 offset:256
    ds_read_b64_tr_b16 v[12:13], v0 offset:16
    ds_read_b64_tr_b16 v[14:15], v0 offset:272
    ds_read_b64_tr_b16 v[16:17], v0 offset:8256
    ds_read_b64_tr_b16 v[18:19], v0 offset:8512
    ds_read_b64_tr_b16 v[20:21], v0 offset:8272
    ds_read_b64_tr_b16 v[22:23], v0 offset:8528
    ds_read_b64_tr_b16 v[24:25], v0 offset:4128
    ds_read_b64_tr_b16 v[26:27], v0 offset:4384
    ds_read_b64_tr_b16 v[28:29], v0 offset:4144
    ds_read_b64_tr_b16 v[30:31], v0 offset:4400
    s_waitcnt lgkmcnt(10)
    v_mfma_f32_16x16x32_bf16 v[32:35], v[8:11], v[128:131], 0
    v_mfma_f32_16x16x32_bf16 v[40:43], v[8:11], v[132:135], 0
    ds_read_b64_tr_b16 v[8:9], v0 offset:12384
    s_waitcnt lgkmcnt(9)
    v_mfma_f32_16x16x32_bf16 v[36:39], v[12:15], v[128:131], 0
    ds_read_b64_tr_b16 v[10:11], v0 offset:12640
    v_mfma_f32_16x16x32_bf16 v[44:47], v[12:15], v[132:135], 0
    ds_read_b64_tr_b16 v[12:13], v0 offset:12400
    s_waitcnt lgkmcnt(9)
    v_mfma_f32_16x16x32_bf16 v[48:51], v[16:19], v[128:131], 0
    ds_read_b64_tr_b16 v[14:15], v0 offset:12656
    v_mfma_f32_16x16x32_bf16 v[56:59], v[16:19], v[132:135], 0
    ds_read_b64_tr_b16 v[16:17], v0 offset:512
    s_waitcnt lgkmcnt(9)
    v_mfma_f32_16x16x32_bf16 v[52:55], v[20:23], v[128:131], 0
    ds_read_b64_tr_b16 v[18:19], v0 offset:768
    v_mfma_f32_16x16x32_bf16 v[60:63], v[20:23], v[132:135], 0
    ds_read_b64_tr_b16 v[20:21], v0 offset:528
    s_waitcnt lgkmcnt(9)
    v_mfma_f32_16x16x32_bf16 v[32:35], v[24:27], v[136:139], v[32:35]
    ds_read_b64_tr_b16 v[22:23], v0 offset:784
    v_mfma_f32_16x16x32_bf16 v[40:43], v[24:27], v[140:143], v[40:43]
    ds_read_b64_tr_b16 v[24:25], v0 offset:8768
    s_waitcnt lgkmcnt(9)
    v_mfma_f32_16x16x32_bf16 v[36:39], v[28:31], v[136:139], v[36:39]
    ds_read_b64_tr_b16 v[26:27], v0 offset:9024
    v_mfma_f32_16x16x32_bf16 v[44:47], v[28:31], v[140:143], v[44:47]
    ds_read_b64_tr_b16 v[28:29], v0 offset:8784
    s_waitcnt lgkmcnt(9)
    v_mfma_f32_16x16x32_bf16 v[48:51], v[8:11], v[136:139], v[48:51]
    ds_read_b64_tr_b16 v[30:31], v0 offset:9040
    v_mfma_f32_16x16x32_bf16 v[56:59], v[8:11], v[140:143], v[56:59]
    s_waitcnt vmcnt(4)
    s_lshl_b32 s62, s45, 1
    s_lshr_b32 s63, s47, 1
    s_add_u32 s62, s62, s63
    s_lshl_b32 s62, s62, 2
    s_lshr_b32 s63, s44, 2
    s_add_u32 s62, s62, s63
    s_lshl_b32 s62, s62, 7
    s_add_u32 s62, s62, 12599296
    s_atomic_add s71, s[40:41], s62
    s_add_u32 s58, s51, 3
    s_and_b32 s58, s58, 3
    s_add_u32 s58, s58, s48
    s_and_b32 s58, s58, 3
    s_mul_i32 s59, s58, 176128
    s_add_u32 s59, s59, s60
    s_add_u32 s58, s59, 22016
    s_add_u32 m0, s61, 49536
    s_nop 0
    buffer_load_dwordx4 v3, s[16:19], s59 offen  lds
    s_add_u32 m0, s61, 50560
    s_nop 0
    buffer_load_dwordx4 v3, s[16:19], s58 offen  lds
    s_add_u32 m0, s61, 57792
    s_nop 0
    buffer_load_dwordx4 v3, s[20:23], s59 offen  lds
    s_add_u32 m0, s61, 58816
    s_nop 0
    buffer_load_dwordx4 v3, s[20:23], s58 offen  lds
    ds_read_b64_tr_b16 v[8:9], v0 offset:4640
    s_waitcnt lgkmcnt(9)
    v_mfma_f32_16x16x32_bf16 v[52:55], v[12:15], v[136:139], v[52:55]
    ds_read_b64_tr_b16 v[10:11], v0 offset:4896
    v_mfma_f32_16x16x32_bf16 v[60:63], v[12:15], v[140:143], v[60:63]
    ds_read_b64_tr_b16 v[12:13], v0 offset:4656
    s_waitcnt lgkmcnt(9)
    v_mfma_f32_16x16x32_bf16 v[32:35], v[16:19], v[192:195], v[32:35]
    ds_read_b64_tr_b16 v[14:15], v0 offset:4912
    v_mfma_f32_16x16x32_bf16 v[40:43], v[16:19], v[196:199], v[40:43]
    ds_read_b64_tr_b16 v[16:17], v0 offset:12896
    s_waitcnt lgkmcnt(9)
    v_mfma_f32_16x16x32_bf16 v[36:39], v[20:23], v[192:195], v[36:39]
    ds_read_b64_tr_b16 v[18:19], v0 offset:13152
    v_mfma_f32_16x16x32_bf16 v[44:47], v[20:23], v[196:199], v[44:47]
    ds_read_b64_tr_b16 v[20:21], v0 offset:12912
    s_waitcnt lgkmcnt(9)
    v_mfma_f32_16x16x32_bf16 v[48:51], v[24:27], v[192:195], v[48:51]
    ds_read_b64_tr_b16 v[22:23], v0 offset:13168
    v_mfma_f32_16x16x32_bf16 v[56:59], v[24:27], v[196:199], v[56:59]
    ds_read_b64_tr_b16 v[24:25], v0 offset:16512
    s_waitcnt lgkmcnt(9)
    v_mfma_f32_16x16x32_bf16 v[52:55], v[28:31], v[192:195], v[52:55]
    ds_read_b64_tr_b16 v[26:27], v0 offset:16768
    v_mfma_f32_16x16x32_bf16 v[60:63], v[28:31], v[196:199], v[60:63]
    ds_read_b64_tr_b16 v[28:29], v0 offset:16528
    s_waitcnt lgkmcnt(9)
    v_mfma_f32_16x16x32_bf16 v[32:35], v[8:11], v[200:203], v[32:35]
    ds_read_b64_tr_b16 v[30:31], v0 offset:16784
    v_mfma_f32_16x16x32_bf16 v[40:43], v[8:11], v[204:207], v[40:43]
    ds_read_b64_tr_b16 v[8:9], v0 offset:24768
    s_waitcnt lgkmcnt(9)
    v_mfma_f32_16x16x32_bf16 v[36:39], v[12:15], v[200:203], v[36:39]
    ds_read_b64_tr_b16 v[10:11], v0 offset:25024
    v_mfma_f32_16x16x32_bf16 v[44:47], v[12:15], v[204:207], v[44:47]
    ds_read_b64_tr_b16 v[12:13], v0 offset:24784
    s_waitcnt lgkmcnt(9)
    v_mfma_f32_16x16x32_bf16 v[48:51], v[16:19], v[200:203], v[48:51]
    ds_read_b64_tr_b16 v[14:15], v0 offset:25040
    v_mfma_f32_16x16x32_bf16 v[56:59], v[16:19], v[204:207], v[56:59]
    ds_read_b64_tr_b16 v[16:17], v0 offset:20640
    s_waitcnt lgkmcnt(9)
    v_mfma_f32_16x16x32_bf16 v[52:55], v[20:23], v[200:203], v[52:55]
    ds_read_b64_tr_b16 v[18:19], v0 offset:20896
    v_mfma_f32_16x16x32_bf16 v[60:63], v[20:23], v[204:207], v[60:63]
    ds_read_b64_tr_b16 v[20:21], v0 offset:20656
    s_waitcnt lgkmcnt(9)
    v_mfma_f32_16x16x32_bf16 v[32:35], v[24:27], v[144:147], v[32:35]
    ds_read_b64_tr_b16 v[22:23], v0 offset:20912
    v_mfma_f32_16x16x32_bf16 v[40:43], v[24:27], v[148:151], v[40:43]
    ds_read_b64_tr_b16 v[24:25], v0 offset:28896
    s_waitcnt lgkmcnt(9)
    v_mfma_f32_16x16x32_bf16 v[36:39], v[28:31], v[144:147], v[36:39]
    ds_read_b64_tr_b16 v[26:27], v0 offset:29152
    v_mfma_f32_16x16x32_bf16 v[44:47], v[28:31], v[148:151], v[44:47]
    ds_read_b64_tr_b16 v[28:29], v0 offset:28912
    s_waitcnt lgkmcnt(9)
    v_mfma_f32_16x16x32_bf16 v[48:51], v[8:11], v[144:147], v[48:51]
    ds_read_b64_tr_b16 v[30:31], v0 offset:29168
    v_mfma_f32_16x16x32_bf16 v[56:59], v[8:11], v[148:151], v[56:59]
    ds_read_b64_tr_b16 v[8:9], v0 offset:17024
    s_waitcnt lgkmcnt(9)
    v_mfma_f32_16x16x32_bf16 v[52:55], v[12:15], v[144:147], v[52:55]
    ds_read_b64_tr_b16 v[10:11], v0 offset:17280
    v_mfma_f32_16x16x32_bf16 v[60:63], v[12:15], v[148:151], v[60:63]
    ds_read_b64_tr_b16 v[12:13], v0 offset:17040
    s_waitcnt lgkmcnt(9)
    v_mfma_f32_16x16x32_bf16 v[32:35], v[16:19], v[152:155], v[32:35]
    ds_read_b64_tr_b16 v[14:15], v0 offset:17296
    v_mfma_f32_16x16x32_bf16 v[40:43], v[16:19], v[156:159], v[40:43]
    s_waitcnt vmcnt(0)
    s_mov_b64 exec, 1
    ds_add_u32 v5, v6 offset:0
    s_mov_b64 exec, -1
    ds_read_b64_tr_b16 v[16:17], v0 offset:25280
    s_waitcnt lgkmcnt(10)
    v_mfma_f32_16x16x32_bf16 v[36:39], v[20:23], v[152:155], v[36:39]
    ds_read_b64_tr_b16 v[18:19], v0 offset:25536
    v_mfma_f32_16x16x32_bf16 v[44:47], v[20:23], v[156:159], v[44:47]
    ds_read_b64_tr_b16 v[20:21], v0 offset:25296
    s_waitcnt lgkmcnt(10)
    v_mfma_f32_16x16x32_bf16 v[48:51], v[24:27], v[152:155], v[48:51]
    ds_read_b64_tr_b16 v[22:23], v0 offset:25552
    v_mfma_f32_16x16x32_bf16 v[56:59], v[24:27], v[156:159], v[56:59]
    ds_read_b64_tr_b16 v[24:25], v0 offset:21152
    s_waitcnt lgkmcnt(10)
    v_mfma_f32_16x16x32_bf16 v[52:55], v[28:31], v[152:155], v[52:55]
    ds_read_b64_tr_b16 v[26:27], v0 offset:21408
    v_mfma_f32_16x16x32_bf16 v[60:63], v[28:31], v[156:159], v[60:63]
    ds_read_b64_tr_b16 v[28:29], v0 offset:21168
    s_waitcnt lgkmcnt(10)
    v_mfma_f32_16x16x32_bf16 v[32:35], v[8:11], v[208:211], v[32:35]
    ds_read_b64_tr_b16 v[30:31], v0 offset:21424
    v_mfma_f32_16x16x32_bf16 v[40:43], v[8:11], v[212:215], v[40:43]
    ds_read_b32 v7, v5 offset:0
    ds_read_b64_tr_b16 v[8:9], v0 offset:29408
    s_waitcnt lgkmcnt(11)
    v_mfma_f32_16x16x32_bf16 v[36:39], v[12:15], v[208:211], v[36:39]
    ds_read_b64_tr_b16 v[10:11], v0 offset:29664
    v_mfma_f32_16x16x32_bf16 v[44:47], v[12:15], v[212:215], v[44:47]
    ds_read_b64_tr_b16 v[12:13], v0 offset:29424
    s_waitcnt lgkmcnt(10)
    v_mfma_f32_16x16x32_bf16 v[48:51], v[16:19], v[208:211], v[48:51]
    ds_read_b64_tr_b16 v[14:15], v0 offset:29680
    v_mfma_f32_16x16x32_bf16 v[56:59], v[16:19], v[212:215], v[56:59]
    s_waitcnt lgkmcnt(4)
    v_cmp_gt_u32 vcc, 160, v7
    s_cbranch_vccz L_ldone_40
    s_mov_b32 s70, 1000000
L_lspin_39:
    ds_read_b32 v7, v5 offset:0
    s_waitcnt lgkmcnt(0)
    v_cmp_gt_u32 vcc, 160, v7
    s_cbranch_vccz L_ldone_40
    s_sub_u32 s70, s70, 1
    s_cmp_lg_u32 s70, 0
    s_cbranch_scc1 L_lspin_39
L_ldone_40:
    ds_read_b64_tr_b16 v[16:17], v0 offset:33024
    v_mfma_f32_16x16x32_bf16 v[52:55], v[20:23], v[208:211], v[52:55]
    ds_read_b64_tr_b16 v[18:19], v0 offset:33280
    v_mfma_f32_16x16x32_bf16 v[60:63], v[20:23], v[212:215], v[60:63]
    ds_read_b64_tr_b16 v[20:21], v0 offset:33040
    v_mfma_f32_16x16x32_bf16 v[32:35], v[24:27], v[216:219], v[32:35]
    ds_read_b64_tr_b16 v[22:23], v0 offset:33296
    v_mfma_f32_16x16x32_bf16 v[40:43], v[24:27], v[220:223], v[40:43]
    ds_read_b64_tr_b16 v[24:25], v0 offset:41280
    v_mfma_f32_16x16x32_bf16 v[36:39], v[28:31], v[216:219], v[36:39]
    ds_read_b64_tr_b16 v[26:27], v0 offset:41536
    v_mfma_f32_16x16x32_bf16 v[44:47], v[28:31], v[220:223], v[44:47]
    ds_read_b64_tr_b16 v[28:29], v0 offset:41296
    s_waitcnt lgkmcnt(9)
    v_mfma_f32_16x16x32_bf16 v[48:51], v[8:11], v[216:219], v[48:51]
    ds_read_b64_tr_b16 v[30:31], v0 offset:41552
    v_mfma_f32_16x16x32_bf16 v[56:59], v[8:11], v[220:223], v[56:59]
    ds_read_b64_tr_b16 v[8:9], v0 offset:37152
    s_waitcnt lgkmcnt(9)
    v_mfma_f32_16x16x32_bf16 v[52:55], v[12:15], v[216:219], v[52:55]
    ds_read_b64_tr_b16 v[10:11], v0 offset:37408
    v_mfma_f32_16x16x32_bf16 v[60:63], v[12:15], v[220:223], v[60:63]
    ds_read_b64_tr_b16 v[12:13], v0 offset:37168
    s_waitcnt lgkmcnt(9)
    v_mfma_f32_16x16x32_bf16 v[32:35], v[16:19], v[160:163], v[32:35]
    ds_read_b64_tr_b16 v[14:15], v0 offset:37424
    v_mfma_f32_16x16x32_bf16 v[40:43], v[16:19], v[164:167], v[40:43]
    ds_read_b64_tr_b16 v[16:17], v0 offset:45408
    s_waitcnt lgkmcnt(9)
    v_mfma_f32_16x16x32_bf16 v[36:39], v[20:23], v[160:163], v[36:39]
    ds_read_b64_tr_b16 v[18:19], v0 offset:45664
    v_mfma_f32_16x16x32_bf16 v[44:47], v[20:23], v[164:167], v[44:47]
    ds_read_b64_tr_b16 v[20:21], v0 offset:45424
    s_waitcnt lgkmcnt(9)
    v_mfma_f32_16x16x32_bf16 v[48:51], v[24:27], v[160:163], v[48:51]
    ds_read_b64_tr_b16 v[22:23], v0 offset:45680
    v_mfma_f32_16x16x32_bf16 v[56:59], v[24:27], v[164:167], v[56:59]
    ds_read_b64_tr_b16 v[24:25], v0 offset:33536
    s_waitcnt lgkmcnt(9)
    v_mfma_f32_16x16x32_bf16 v[52:55], v[28:31], v[160:163], v[52:55]
    ds_read_b64_tr_b16 v[26:27], v0 offset:33792
    v_mfma_f32_16x16x32_bf16 v[60:63], v[28:31], v[164:167], v[60:63]
    ds_read_b64_tr_b16 v[28:29], v0 offset:33552
    s_waitcnt lgkmcnt(9)
    v_mfma_f32_16x16x32_bf16 v[32:35], v[8:11], v[168:171], v[32:35]
    ds_read_b64_tr_b16 v[30:31], v0 offset:33808
    v_mfma_f32_16x16x32_bf16 v[40:43], v[8:11], v[172:175], v[40:43]
    ds_read_b64_tr_b16 v[8:9], v0 offset:41792
    s_waitcnt lgkmcnt(9)
    v_mfma_f32_16x16x32_bf16 v[36:39], v[12:15], v[168:171], v[36:39]
    ds_read_b64_tr_b16 v[10:11], v0 offset:42048
    v_mfma_f32_16x16x32_bf16 v[44:47], v[12:15], v[172:175], v[44:47]
    ds_read_b64_tr_b16 v[12:13], v0 offset:41808
    s_waitcnt lgkmcnt(9)
    v_mfma_f32_16x16x32_bf16 v[48:51], v[16:19], v[168:171], v[48:51]
    ds_read_b64_tr_b16 v[14:15], v0 offset:42064
    v_mfma_f32_16x16x32_bf16 v[56:59], v[16:19], v[172:175], v[56:59]
    ds_read_b64_tr_b16 v[16:17], v0 offset:37664
    s_waitcnt lgkmcnt(9)
    v_mfma_f32_16x16x32_bf16 v[52:55], v[20:23], v[168:171], v[52:55]
    ds_read_b64_tr_b16 v[18:19], v0 offset:37920
    v_mfma_f32_16x16x32_bf16 v[60:63], v[20:23], v[172:175], v[60:63]
    ds_read_b64_tr_b16 v[20:21], v0 offset:37680
    s_waitcnt lgkmcnt(9)
    v_mfma_f32_16x16x32_bf16 v[32:35], v[24:27], v[224:227], v[32:35]
    ds_read_b64_tr_b16 v[22:23], v0 offset:37936
    v_mfma_f32_16x16x32_bf16 v[40:43], v[24:27], v[228:231], v[40:43]
    ds_read_b64_tr_b16 v[24:25], v0 offset:45920
    s_waitcnt lgkmcnt(9)
    v_mfma_f32_16x16x32_bf16 v[36:39], v[28:31], v[224:227], v[36:39]
    ds_read_b64_tr_b16 v[26:27], v0 offset:46176
    v_mfma_f32_16x16x32_bf16 v[44:47], v[28:31], v[228:231], v[44:47]
    ds_read_b64_tr_b16 v[28:29], v0 offset:45936
    s_waitcnt lgkmcnt(9)
    v_mfma_f32_16x16x32_bf16 v[48:51], v[8:11], v[224:227], v[48:51]
    ds_read_b64_tr_b16 v[30:31], v0 offset:46192
    v_mfma_f32_16x16x32_bf16 v[56:59], v[8:11], v[228:231], v[56:59]
    ds_read_b64_tr_b16 v[8:9], v0 offset:49536
    s_waitcnt lgkmcnt(9)
    v_mfma_f32_16x16x32_bf16 v[52:55], v[12:15], v[224:227], v[52:55]
    ds_read_b64_tr_b16 v[10:11], v0 offset:49792
    v_mfma_f32_16x16x32_bf16 v[60:63], v[12:15], v[228:231], v[60:63]
    ds_read_b64_tr_b16 v[12:13], v0 offset:49552
    s_waitcnt lgkmcnt(9)
    v_mfma_f32_16x16x32_bf16 v[32:35], v[16:19], v[232:235], v[32:35]
    ds_read_b64_tr_b16 v[14:15], v0 offset:49808
    v_mfma_f32_16x16x32_bf16 v[40:43], v[16:19], v[236:239], v[40:43]
    ds_read_b64_tr_b16 v[16:17], v0 offset:57792
    s_waitcnt lgkmcnt(9)
    v_mfma_f32_16x16x32_bf16 v[36:39], v[20:23], v[232:235], v[36:39]
    ds_read_b64_tr_b16 v[18:19], v0 offset:58048
    v_mfma_f32_16x16x32_bf16 v[44:47], v[20:23], v[236:239], v[44:47]
    ds_read_b64_tr_b16 v[20:21], v0 offset:57808
    s_waitcnt lgkmcnt(9)
    v_mfma_f32_16x16x32_bf16 v[48:51], v[24:27], v[232:235], v[48:51]
    ds_read_b64_tr_b16 v[22:23], v0 offset:58064
    v_mfma_f32_16x16x32_bf16 v[56:59], v[24:27], v[236:239], v[56:59]
    ds_read_b64_tr_b16 v[24:25], v0 offset:53664
    s_waitcnt lgkmcnt(9)
    v_mfma_f32_16x16x32_bf16 v[52:55], v[28:31], v[232:235], v[52:55]
    ds_read_b64_tr_b16 v[26:27], v0 offset:53920
    v_mfma_f32_16x16x32_bf16 v[60:63], v[28:31], v[236:239], v[60:63]
    ds_read_b64_tr_b16 v[28:29], v0 offset:53680
    s_waitcnt lgkmcnt(9)
    v_mfma_f32_16x16x32_bf16 v[32:35], v[8:11], v[176:179], v[32:35]
    ds_read_b64_tr_b16 v[30:31], v0 offset:53936
    v_mfma_f32_16x16x32_bf16 v[40:43], v[8:11], v[180:183], v[40:43]
    s_mov_b64 exec, 1
    ds_add_u32 v5, v6 offset:28
    s_mov_b64 exec, -1
    s_mul_i32 s54, s47, 12352
    s_mul_i32 s4, s47, 6144
    s_add_u32 s4, s4, 49408
    s_and_b32 s57, s49, 3
    s_lshl_b32 s57, s57, 1
    s_add_u32 s57, s57, s50
    s_lshl_b32 s57, s57, 1
    s_and_b32 s57, s57, 15
    s_mov_b32 s59, s57
    s_lshl_b32 s58, s47, 18
    s_lshl_b32 s55, s50, 7
    s_add_u32 s58, s58, s55
    s_mul_i32 s60, s49, 172
    s_lshl_b32 s55, s47, 4
    s_add_u32 s60, s60, s55
    s_lshl_b32 s60, s60, 10
    s_add_u32 s60, s60, 6291456
    ds_read_b64_tr_b16 v[8:9], v0 offset:61920
    s_waitcnt lgkmcnt(10)
    v_mfma_f32_16x16x32_bf16 v[36:39], v[12:15], v[176:179], v[36:39]
    ds_read_b64_tr_b16 v[10:11], v0 offset:62176
    v_mfma_f32_16x16x32_bf16 v[44:47], v[12:15], v[180:183], v[44:47]
    ds_read_b64_tr_b16 v[12:13], v0 offset:61936
    s_waitcnt lgkmcnt(10)
    v_mfma_f32_16x16x32_bf16 v[48:51], v[16:19], v[176:179], v[48:51]
    ds_read_b64_tr_b16 v[14:15], v0 offset:62192
    v_mfma_f32_16x16x32_bf16 v[56:59], v[16:19], v[180:183], v[56:59]
    ds_read_b32 v7, v5 offset:28
    ds_read_b64_tr_b16 v[16:17], v0 offset:50048
    s_waitcnt lgkmcnt(11)
    v_mfma_f32_16x16x32_bf16 v[52:55], v[20:23], v[176:179], v[52:55]
    ds_read_b64_tr_b16 v[18:19], v0 offset:50304
    v_mfma_f32_16x16x32_bf16 v[60:63], v[20:23], v[180:183], v[60:63]
    ds_read_b64_tr_b16 v[20:21], v0 offset:50064
    s_waitcnt lgkmcnt(11)
    v_mfma_f32_16x16x32_bf16 v[32:35], v[24:27], v[184:187], v[32:35]
    ds_read_b64_tr_b16 v[22:23], v0 offset:50320
    v_mfma_f32_16x16x32_bf16 v[40:43], v[24:27], v[188:191], v[40:43]
    s_waitcnt lgkmcnt(4)
    v_cmp_gt_u32 vcc, 16, v7
    s_cbranch_vccz L_ldone_42
    s_mov_b32 s70, 1000000
L_lspin_41:
    ds_read_b32 v7, v5 offset:28
    s_waitcnt lgkmcnt(0)
    v_cmp_gt_u32 vcc, 16, v7
    s_cbranch_vccz L_ldone_42
    s_sub_u32 s70, s70, 1
    s_cmp_lg_u32 s70, 0
    s_cbranch_scc1 L_lspin_41
L_ldone_42:
    s_add_u32 m0, s54, 0
    s_lshl_b32 s56, s57, 14
    s_add_u32 s56, s56, s58
    buffer_load_dwordx4 v1, s[24:27], s56 offen lds
    buffer_load_dwordx4 v2, s[24:27], s56 offen offset:1024 lds
    ds_read_b64_tr_b16 v[24:25], v0 offset:58304
    v_mfma_f32_16x16x32_bf16 v[36:39], v[28:31], v[184:187], v[36:39]
    ds_read_b64_tr_b16 v[26:27], v0 offset:58560
    v_mfma_f32_16x16x32_bf16 v[44:47], v[28:31], v[188:191], v[44:47]
    ds_read_b64_tr_b16 v[28:29], v0 offset:58320
    v_mfma_f32_16x16x32_bf16 v[48:51], v[8:11], v[184:187], v[48:51]
    ds_read_b64_tr_b16 v[30:31], v0 offset:58576
    v_mfma_f32_16x16x32_bf16 v[56:59], v[8:11], v[188:191], v[56:59]
    s_add_u32 m0, s54, 2064
    s_add_u32 s57, s57, 1
    s_and_b32 s57, s57, 15
    s_lshl_b32 s56, s57, 14
    s_add_u32 s56, s56, s58
    buffer_load_dwordx4 v1, s[24:27], s56 offen lds
    buffer_load_dwordx4 v2, s[24:27], s56 offen offset:1024 lds
    ds_read_b64_tr_b16 v[8:9], v0 offset:54176
    v_mfma_f32_16x16x32_bf16 v[52:55], v[12:15], v[184:187], v[52:55]
    ds_read_b64_tr_b16 v[10:11], v0 offset:54432
    v_mfma_f32_16x16x32_bf16 v[60:63], v[12:15], v[188:191], v[60:63]
    ds_read_b64_tr_b16 v[12:13], v0 offset:54192
    s_waitcnt lgkmcnt(9)
    v_mfma_f32_16x16x32_bf16 v[32:35], v[16:19], v[240:243], v[32:35]
    ds_read_b64_tr_b16 v[14:15], v0 offset:54448
    v_mfma_f32_16x16x32_bf16 v[40:43], v[16:19], v[244:247], v[40:43]
    s_add_u32 m0, s54, 4112
    s_add_u32 s57, s57, 1
    s_and_b32 s57, s57, 15
    s_lshl_b32 s56, s57, 14
    s_add_u32 s56, s56, s58
    buffer_load_dwordx4 v1, s[24:27], s56 offen lds
    buffer_load_dwordx4 v2, s[24:27], s56 offen offset:1024 lds
    ds_read_b64_tr_b16 v[16:17], v0 offset:62432
    s_waitcnt lgkmcnt(9)
    v_mfma_f32_16x16x32_bf16 v[36:39], v[20:23], v[240:243], v[36:39]
    ds_read_b64_tr_b16 v[18:19], v0 offset:62688
    v_mfma_f32_16x16x32_bf16 v[44:47], v[20:23], v[244:247], v[44:47]
    ds_read_b64_tr_b16 v[20:21], v0 offset:62448
    s_waitcnt lgkmcnt(9)
    v_mfma_f32_16x16x32_bf16 v[48:51], v[24:27], v[240:243], v[48:51]
    ds_read_b64_tr_b16 v[22:23], v0 offset:62704
    v_mfma_f32_16x16x32_bf16 v[56:59], v[24:27], v[244:247], v[56:59]
    s_add_u32 m0, s54, 6176
    s_add_u32 s57, s57, 1
    s_and_b32 s57, s57, 15
    s_lshl_b32 s56, s57, 14
    s_add_u32 s56, s56, s58
    buffer_load_dwordx4 v1, s[24:27], s56 offen lds
    buffer_load_dwordx4 v2, s[24:27], s56 offen offset:1024 lds
    s_waitcnt lgkmcnt(8)
    v_mfma_f32_16x16x32_bf16 v[52:55], v[28:31], v[240:243], v[52:55]
    v_mfma_f32_16x16x32_bf16 v[60:63], v[28:31], v[244:247], v[60:63]
    s_waitcnt lgkmcnt(6)
    v_mfma_f32_16x16x32_bf16 v[32:35], v[8:11], v[248:251], v[32:35]
    v_mfma_f32_16x16x32_bf16 v[40:43], v[8:11], v[252:255], v[40:43]
    s_add_u32 m0, s54, 8224
    s_add_u32 s57, s57, 1
    s_and_b32 s57, s57, 15
    s_lshl_b32 s56, s57, 14
    s_add_u32 s56, s56, s58
    buffer_load_dwordx4 v1, s[24:27], s56 offen lds
    buffer_load_dwordx4 v2, s[24:27], s56 offen offset:1024 lds
    s_waitcnt lgkmcnt(4)
    v_mfma_f32_16x16x32_bf16 v[36:39], v[12:15], v[248:251], v[36:39]
    v_mfma_f32_16x16x32_bf16 v[44:47], v[12:15], v[252:255], v[44:47]
    s_waitcnt lgkmcnt(2)
    v_mfma_f32_16x16x32_bf16 v[48:51], v[16:19], v[248:251], v[48:51]
    v_mfma_f32_16x16x32_bf16 v[56:59], v[16:19], v[252:255], v[56:59]
    s_add_u32 m0, s54, 10288
    s_add_u32 s57, s57, 1
    s_and_b32 s57, s57, 15
    s_lshl_b32 s56, s57, 14
    s_add_u32 s56, s56, s58
    buffer_load_dwordx4 v1, s[24:27], s56 offen lds
    buffer_load_dwordx4 v2, s[24:27], s56 offen offset:1024 lds
    s_waitcnt lgkmcnt(0)
    v_mfma_f32_16x16x32_bf16 v[52:55], v[20:23], v[248:251], v[52:55]
    v_mfma_f32_16x16x32_bf16 v[60:63], v[20:23], v[252:255], v[60:63]
    s_mov_b64 exec, 1
    ds_add_u32 v5, v6 offset:0
    s_mov_b64 exec, -1
    s_setprio 3
    s_lshl_b32 s66, s45, 2
    s_add_u32 s66, s66, s47
    s_mul_i32 s66, s66, 86
    s_lshl_b32 s67, s53, 1
    s_add_u32 s67, s67, 64
    s_add_u32 s66, s66, s67
    s_lshl_b32 s66, s66, 10
    s_add_u32 s66, s66, 6291456
    v_mbcnt_lo_u32_b32 v8, -1, 0
    v_mbcnt_hi_u32_b32 v8, -1, v8
    v_lshlrev_b32 v16, 4, v8
    s_and_b32 s55, s47, 1
    s_mul_i32 s55, s55, 88064
    v_bfe_u32 v22, v8, 4, 1
    v_mul_u32_u24 v20, 768, v22
    v_add_u32 v20, v20, v16
    v_add_u32 v10, s55, v20
    s_sub_u32 s55, 88064, s55
    v_add_u32 v19, s55, v20
    v_add_u32 v15, s54, v16
    v_lshrrev_b32 v20, 5, v8
    v_bfe_u32 v21, v8, 2, 2
    v_lshl_add_u32 v20, v20, 2, v21
    v_and_b32 v21, 1, v8
    v_lshlrev_b32 v21, 2, v21
    v_lshl_add_u32 v21, v22, 1, v21
    v_bfe_u32 v23, v8, 1, 1
    v_add_u32 v21, v21, v23
    v_lshlrev_b32 v21, 3, v21
    v_lshl_add_u32 v21, v20, 7, v21
    v_bfe_u32 v23, v8, 3, 1
    v_lshl_add_u32 v21, v23, 6, v21
    s_lshr_b32 s55, s47, 1
    s_lshl_b32 s55, s55, 6
    v_xor_b32 v9, s55, v21
    v_and_b32 v20, 0x3d0, v9
    v_lshl_add_u32 v20, v22, 11, v20
    v_and_b32 v21, 1, v8
    v_lshl_add_u32 v20, v21, 3, v20
    v_and_b32 v21, 2, v8
    v_lshl_add_u32 v20, v21, 4, v20
    v_xor_b32 v21, 64, v20
    v_add_u32 v11, s54, v20
    v_add_u32 v12, s54, v21
    v_add_u32 v14, s4, v20
    v_add_u32 v18, s4, v21
    s_lshl_b32 s55, s47, 2
    v_add_u32 v13, s55, v5
    v_and_b32 v17, 31, v8
    v_lshlrev_b32 v30, 10, v17
    v_lshlrev_b32 v17, 2, v17
    v_lshrrev_b32 v20, 5, v8
    v_lshl_add_u32 v30, v20, 5, v30
    v_add_u32 v31, s4, v16
    s_xor_b32 s55, s47, 2
    s_mul_i32 s55, s55, 6144
    s_add_u32 s55, s55, 49408
    v_add_u32 v20, s55, v16
    s_xor_b32 s55, s47, 2
    s_mul_i32 s55, s55, 12352
    v_add_u32 v21, s55, v16
    s_xor_b32 s55, s47, 1
    s_mul_i32 s55, s55, 12352
    v_add_u32 v22, s55, v16
    s_xor_b32 s55, s47, 3
    s_mul_i32 s55, s55, 12352
    v_add_u32 v23, s55, v16
.p2align 3
    v_mov_b32 v72, 0xc0135761
    v_mov_b32 v73, 0xc0135761
    v_mov_b32 v74, 0xbdd2d3e8
    v_mov_b32 v75, 0xbdd2d3e8
    v_mul_f32 v96, v32, v32
    v_mul_f32 v97, v33, v33
    v_mul_f32 v98, v34, v34
    v_mul_f32 v99, v35, v35
    v_mul_f32 v100, v36, v36
    v_mul_f32 v101, v37, v37
    v_mul_f32 v102, v38, v38
    v_mul_f32 v103, v39, v39
    v_mul_f32 v104, v40, v40
    v_mul_f32 v105, v41, v41
    v_mul_f32 v106, v42, v42
    v_mul_f32 v107, v43, v43
    v_mul_f32 v108, v44, v44
    v_mul_f32 v109, v45, v45
    v_mul_f32 v110, v46, v46
    v_mul_f32 v111, v47, v47
    v_pk_fma_f32 v[96:97], v[96:97], v[74:75], v[72:73]
    v_pk_fma_f32 v[98:99], v[98:99], v[74:75], v[72:73]
    v_pk_fma_f32 v[100:101], v[100:101], v[74:75], v[72:73]
    v_pk_fma_f32 v[102:103], v[102:103], v[74:75], v[72:73]
    v_pk_fma_f32 v[104:105], v[104:105], v[74:75], v[72:73]
    v_pk_fma_f32 v[106:107], v[106:107], v[74:75], v[72:73]
    v_pk_fma_f32 v[108:109], v[108:109], v[74:75], v[72:73]
    v_pk_fma_f32 v[110:111], v[110:111], v[74:75], v[72:73]
    v_pk_mul_f32 v[96:97], v[96:97], v[32:33]
    v_pk_mul_f32 v[98:99], v[98:99], v[34:35]
    v_pk_mul_f32 v[100:101], v[100:101], v[36:37]
    v_pk_mul_f32 v[102:103], v[102:103], v[38:39]
    v_pk_mul_f32 v[104:105], v[104:105], v[40:41]
    v_pk_mul_f32 v[106:107], v[106:107], v[42:43]
    v_pk_mul_f32 v[108:109], v[108:109], v[44:45]
    v_pk_mul_f32 v[110:111], v[110:111], v[46:47]
    ds_read_b32 v7, v5 offset:0
.p2align 3
    v_exp_f32 v96, v96
    v_exp_f32 v97, v97
    v_exp_f32 v98, v98
    v_exp_f32 v99, v99
    v_exp_f32 v100, v100
    v_exp_f32 v101, v101
    v_exp_f32 v102, v102
    v_exp_f32 v103, v103
    v_exp_f32 v104, v104
    v_exp_f32 v105, v105
    v_exp_f32 v106, v106
    v_exp_f32 v107, v107
    v_exp_f32 v108, v108
    v_exp_f32 v109, v109
    v_exp_f32 v110, v110
    v_exp_f32 v111, v111
    v_pk_mul_f32 v[32:33], v[32:33], v[48:49]
    v_pk_mul_f32 v[34:35], v[34:35], v[50:51]
    v_pk_mul_f32 v[36:37], v[36:37], v[52:53]
    v_pk_mul_f32 v[38:39], v[38:39], v[54:55]
    v_pk_mul_f32 v[40:41], v[40:41], v[56:57]
    v_pk_mul_f32 v[42:43], v[42:43], v[58:59]
    v_pk_mul_f32 v[44:45], v[44:45], v[60:61]
    v_pk_mul_f32 v[46:47], v[46:47], v[62:63]
    v_pk_add_f32 v[96:97], v[96:97], 1.0 op_sel_hi:[1,0]
    v_pk_add_f32 v[98:99], v[98:99], 1.0 op_sel_hi:[1,0]
    v_pk_add_f32 v[100:101], v[100:101], 1.0 op_sel_hi:[1,0]
    v_pk_add_f32 v[102:103], v[102:103], 1.0 op_sel_hi:[1,0]
    v_pk_add_f32 v[104:105], v[104:105], 1.0 op_sel_hi:[1,0]
    v_pk_add_f32 v[106:107], v[106:107], 1.0 op_sel_hi:[1,0]
    v_pk_add_f32 v[108:109], v[108:109], 1.0 op_sel_hi:[1,0]
    v_pk_add_f32 v[110:111], v[110:111], 1.0 op_sel_hi:[1,0]
    s_waitcnt lgkmcnt(0)
    v_cmp_gt_u32 vcc, 176, v7
    s_cbranch_vccz L_ldone_44
    s_mov_b32 s70, 1000000
L_lspin_43:
    ds_read_b32 v7, v5 offset:0
    s_waitcnt lgkmcnt(0)
    v_cmp_gt_u32 vcc, 176, v7
    s_cbranch_vccz L_ldone_44
    s_sub_u32 s70, s70, 1
    s_cmp_lg_u32 s70, 0
    s_cbranch_scc1 L_lspin_43
L_ldone_44:
    s_lshl_b32 s64, s49, 2
    s_add_u32 s64, s64, s47
    s_lshl_b32 s64, s64, 7
    s_add_u32 s64, s64, 12599296
    s_mov_b32 s69, 0
    s_atomic_add s69, s[40:41], s64 glc
    s_add_u32 m0, s4, 0
    s_add_u32 s57, s57, 1
    s_and_b32 s57, s57, 15
    s_lshl_b32 s56, s57, 14
    s_add_u32 s56, s56, s58
    buffer_load_dwordx4 v1, s[24:27], s56 offen lds
    buffer_load_dwordx4 v2, s[24:27], s56 offen offset:1024 lds
    s_add_u32 m0, s4, 2064
    s_add_u32 s57, s57, 1
    s_and_b32 s57, s57, 15
    s_lshl_b32 s56, s57, 14
    s_add_u32 s56, s56, s58
    buffer_load_dwordx4 v1, s[24:27], s56 offen lds
    buffer_load_dwordx4 v2, s[24:27], s56 offen offset:1024 lds
.p2align 3
    v_rcp_f32 v96, v96
    v_rcp_f32 v97, v97
    v_rcp_f32 v98, v98
    v_rcp_f32 v99, v99
    v_rcp_f32 v100, v100
    v_rcp_f32 v101, v101
    v_rcp_f32 v102, v102
    v_rcp_f32 v103, v103
    v_rcp_f32 v104, v104
    v_rcp_f32 v105, v105
    v_rcp_f32 v106, v106
    v_rcp_f32 v107, v107
    v_rcp_f32 v108, v108
    v_rcp_f32 v109, v109
    v_rcp_f32 v110, v110
    v_rcp_f32 v111, v111
    v_pk_mul_f32 v[32:33], v[32:33], v[96:97]
    v_pk_mul_f32 v[34:35], v[34:35], v[98:99]
    v_pk_mul_f32 v[36:37], v[36:37], v[100:101]
    v_pk_mul_f32 v[38:39], v[38:39], v[102:103]
    v_pk_mul_f32 v[40:41], v[40:41], v[104:105]
    v_pk_mul_f32 v[42:43], v[42:43], v[106:107]
    v_pk_mul_f32 v[44:45], v[44:45], v[108:109]
    v_pk_mul_f32 v[46:47], v[46:47], v[110:111]
    v_cvt_pk_bf16_f32 v64, v32, v33
    v_cvt_pk_bf16_f32 v65, v34, v35
    v_cvt_pk_bf16_f32 v66, v36, v37
    v_cvt_pk_bf16_f32 v67, v38, v39
    v_cvt_pk_bf16_f32 v68, v40, v41
    v_cvt_pk_bf16_f32 v69, v42, v43
    v_cvt_pk_bf16_f32 v70, v44, v45
    v_cvt_pk_bf16_f32 v71, v46, v47
    buffer_store_dwordx4 v[64:67], v4, s[40:43], s66 offen offset:0 sc1
    buffer_store_dwordx4 v[68:71], v4, s[40:43], s66 offen offset:256 sc1
L_ffn2:
    s_setprio 0
    s_waitcnt lgkmcnt(0)
    s_cmp_ge_u32 s69, 8
    s_cbranch_scc1 L_hready_45
    s_mov_b32 s70, 200000
L_spoll_46:
    s_mov_b32 s69, 0
    s_atomic_add s69, s[40:41], s64 glc
    s_waitcnt lgkmcnt(0)
    s_cmp_ge_u32 s69, 8
    s_cbranch_scc1 L_sdone_47
    s_sub_u32 s70, s70, 1
    s_cmp_lg_u32 s70, 0
    s_cbranch_scc1 L_spoll_46
L_sdone_47:
L_hready_45:
    s_lshl_b32 s55, s59, 10
    s_add_u32 s55, s55, s60
    buffer_load_dwordx4 v[176:179], v10, s[40:43], s55 offen sc1
    buffer_load_dwordx4 v[180:183], v19, s[40:43], s55 offen sc1
    s_add_u32 s59, s59, 1
    s_and_b32 s59, s59, 15
    s_lshl_b32 s55, s59, 10
    s_add_u32 s55, s55, s60
    s_sub_u32 s55, s55, 768
    buffer_load_dwordx4 v[184:187], v10, s[40:43], s55 offen sc1
    buffer_load_dwordx4 v[188:191], v19, s[40:43], s55 offen sc1
    s_add_u32 s59, s59, 1
    s_and_b32 s59, s59, 15
    s_lshl_b32 s55, s59, 10
    s_add_u32 s55, s55, s60
    buffer_load_dwordx4 v[192:195], v10, s[40:43], s55 offen sc1
    buffer_load_dwordx4 v[196:199], v19, s[40:43], s55 offen sc1
    s_waitcnt vmcnt(6)
    ds_read_b64_tr_b16 v[96:97], v11 offset:0
    ds_read_b64_tr_b16 v[98:99], v11 offset:1024
    ds_read_b64_tr_b16 v[100:101], v12 offset:0
    ds_read_b64_tr_b16 v[102:103], v12 offset:1024
    ds_read_b64_tr_b16 v[104:105], v11 offset:16
    ds_read_b64_tr_b16 v[106:107], v11 offset:1040
    ds_read_b64_tr_b16 v[108:109], v12 offset:16
    ds_read_b64_tr_b16 v[110:111], v12 offset:1040
    s_cmp_ge_u32 s53, 11
    s_cbranch_scc1 L_nosig_48
    s_lshl_b32 s62, s45, 1
    s_lshr_b32 s63, s47, 1
    s_add_u32 s62, s62, s63
    s_lshl_b32 s62, s62, 2
    s_mul_i32 s63, s53, 11
    s_lshr_b32 s63, s63, 5
    s_add_u32 s62, s62, s63
    s_lshl_b32 s62, s62, 7
    s_add_u32 s62, s62, 12648448
    s_atomic_add s71, s[40:41], s62
L_nosig_48:
    s_waitcnt vmcnt(4)
    s_waitcnt lgkmcnt(6)
    v_mfma_f32_16x16x32_bf16 v[32:35], v[96:99], v[176:179], 0
    s_waitcnt lgkmcnt(2)
    v_mfma_f32_16x16x32_bf16 v[40:43], v[104:107], v[176:179], 0
    s_add_u32 s59, s59, 1
    s_and_b32 s59, s59, 15
    s_lshl_b32 s55, s59, 10
    s_add_u32 s55, s55, s60
    s_sub_u32 s55, s55, 768
    buffer_load_dwordx4 v[200:203], v10, s[40:43], s55 offen sc1
    buffer_load_dwordx4 v[204:207], v19, s[40:43], s55 offen sc1
    v_mfma_f32_16x16x32_bf16 v[64:67], v[96:99], v[180:183], 0
    v_mfma_f32_16x16x32_bf16 v[72:75], v[104:107], v[180:183], 0
    ds_read_b64_tr_b16 v[112:113], v11 offset:4112
    ds_read_b64_tr_b16 v[114:115], v11 offset:5136
    ds_read_b64_tr_b16 v[116:117], v12 offset:4112
    ds_read_b64_tr_b16 v[118:119], v12 offset:5136
    v_mfma_f32_16x16x32_bf16 v[48:51], v[100:103], v[176:179], 0
    s_waitcnt lgkmcnt(4)
    v_mfma_f32_16x16x32_bf16 v[56:59], v[108:111], v[176:179], 0
    s_add_u32 m0, s54, 0
    s_add_u32 s57, s57, 1
    s_and_b32 s57, s57, 15
    s_lshl_b32 s56, s57, 14
    s_add_u32 s56, s56, s58
    buffer_load_dwordx4 v1, s[24:27], s56 offen lds
    buffer_load_dwordx4 v2, s[24:27], s56 offen offset:1024 lds
    v_mfma_f32_16x16x32_bf16 v[80:83], v[100:103], v[180:183], 0
    v_mfma_f32_16x16x32_bf16 v[88:91], v[108:111], v[180:183], 0
    s_waitcnt vmcnt(6)
    v_mfma_f32_16x16x32_bf16 v[36:39], v[96:99], v[184:187], 0
    v_mfma_f32_16x16x32_bf16 v[44:47], v[104:107], v[184:187], 0
    s_add_u32 s59, s59, 1
    s_and_b32 s59, s59, 15
    s_lshl_b32 s55, s59, 10
    s_add_u32 s55, s55, s60
    buffer_load_dwordx4 v[208:211], v10, s[40:43], s55 offen sc1
    buffer_load_dwordx4 v[212:215], v19, s[40:43], s55 offen sc1
    v_mfma_f32_16x16x32_bf16 v[68:71], v[96:99], v[188:191], 0
    v_mfma_f32_16x16x32_bf16 v[76:79], v[104:107], v[188:191], 0
    ds_read_b64_tr_b16 v[120:121], v11 offset:4128
    ds_read_b64_tr_b16 v[122:123], v11 offset:5152
    ds_read_b64_tr_b16 v[124:125], v12 offset:4128
    ds_read_b64_tr_b16 v[126:127], v12 offset:5152
    v_mfma_f32_16x16x32_bf16 v[52:55], v[100:103], v[184:187], 0
    v_mfma_f32_16x16x32_bf16 v[60:63], v[108:111], v[184:187], 0
    s_add_u32 m0, s54, 2064
    s_add_u32 s57, s57, 1
    s_and_b32 s57, s57, 15
    s_lshl_b32 s56, s57, 14
    s_add_u32 s56, s56, s58
    buffer_load_dwordx4 v1, s[24:27], s56 offen lds
    buffer_load_dwordx4 v2, s[24:27], s56 offen offset:1024 lds
    v_mfma_f32_16x16x32_bf16 v[84:87], v[100:103], v[188:191], 0
    v_mfma_f32_16x16x32_bf16 v[92:95], v[108:111], v[188:191], 0
    s_waitcnt vmcnt(8)
    s_waitcnt lgkmcnt(6)
    v_mfma_f32_16x16x32_bf16 v[32:35], v[112:115], v[192:195], v[32:35]
    s_waitcnt lgkmcnt(2)
    v_mfma_f32_16x16x32_bf16 v[40:43], v[120:123], v[192:195], v[40:43]
    s_add_u32 s59, s59, 1
    s_and_b32 s59, s59, 15
    s_lshl_b32 s55, s59, 10
    s_add_u32 s55, s55, s60
    s_sub_u32 s55, s55, 768
    buffer_load_dwordx4 v[216:219], v10, s[40:43], s55 offen sc1
    buffer_load_dwordx4 v[220:223], v19, s[40:43], s55 offen sc1
    v_mfma_f32_16x16x32_bf16 v[64:67], v[112:115], v[196:199], v[64:67]
    v_mfma_f32_16x16x32_bf16 v[72:75], v[120:123], v[196:199], v[72:75]
    ds_read_b64_tr_b16 v[96:97], v11 offset:8224
    ds_read_b64_tr_b16 v[98:99], v11 offset:9248
    ds_read_b64_tr_b16 v[100:101], v12 offset:8224
    ds_read_b64_tr_b16 v[102:103], v12 offset:9248
    v_mfma_f32_16x16x32_bf16 v[48:51], v[116:119], v[192:195], v[48:51]
    s_waitcnt lgkmcnt(4)
    v_mfma_f32_16x16x32_bf16 v[56:59], v[124:127], v[192:195], v[56:59]
    s_add_u32 m0, s54, 4112
    s_add_u32 s57, s57, 1
    s_and_b32 s57, s57, 15
    s_lshl_b32 s56, s57, 14
    s_add_u32 s56, s56, s58
    buffer_load_dwordx4 v1, s[24:27], s56 offen lds
    buffer_load_dwordx4 v2, s[24:27], s56 offen offset:1024 lds
    v_mfma_f32_16x16x32_bf16 v[80:83], v[116:119], v[196:199], v[80:83]
    v_mfma_f32_16x16x32_bf16 v[88:91], v[124:127], v[196:199], v[88:91]
    s_waitcnt vmcnt(10)
    v_mfma_f32_16x16x32_bf16 v[36:39], v[112:115], v[200:203], v[36:39]
    v_mfma_f32_16x16x32_bf16 v[44:47], v[120:123], v[200:203], v[44:47]
    s_add_u32 s59, s59, 1
    s_and_b32 s59, s59, 15
    s_lshl_b32 s55, s59, 10
    s_add_u32 s55, s55, s60
    buffer_load_dwordx4 v[224:227], v10, s[40:43], s55 offen sc1
    buffer_load_dwordx4 v[228:231], v19, s[40:43], s55 offen sc1
    v_mfma_f32_16x16x32_bf16 v[68:71], v[112:115], v[204:207], v[68:71]
    v_mfma_f32_16x16x32_bf16 v[76:79], v[120:123], v[204:207], v[76:79]
    ds_read_b64_tr_b16 v[104:105], v11 offset:8240
    ds_read_b64_tr_b16 v[106:107], v11 offset:9264
    ds_read_b64_tr_b16 v[108:109], v12 offset:8240
    ds_read_b64_tr_b16 v[110:111], v12 offset:9264
    v_mfma_f32_16x16x32_bf16 v[52:55], v[116:119], v[200:203], v[52:55]
    v_mfma_f32_16x16x32_bf16 v[60:63], v[124:127], v[200:203], v[60:63]
    s_add_u32 m0, s54, 6176
    s_add_u32 s57, s57, 1
    s_and_b32 s57, s57, 15
    s_lshl_b32 s56, s57, 14
    s_add_u32 s56, s56, s58
    buffer_load_dwordx4 v1, s[24:27], s56 offen lds
    buffer_load_dwordx4 v2, s[24:27], s56 offen offset:1024 lds
    v_mfma_f32_16x16x32_bf16 v[84:87], v[116:119], v[204:207], v[84:87]
    v_mfma_f32_16x16x32_bf16 v[92:95], v[124:127], v[204:207], v[92:95]
    s_waitcnt vmcnt(10)
    s_waitcnt lgkmcnt(6)
    v_mfma_f32_16x16x32_bf16 v[32:35], v[96:99], v[208:211], v[32:35]
    s_waitcnt lgkmcnt(2)
    v_mfma_f32_16x16x32_bf16 v[40:43], v[104:107], v[208:211], v[40:43]
    s_add_u32 s59, s59, 1
    s_and_b32 s59, s59, 15
    s_lshl_b32 s55, s59, 10
    s_add_u32 s55, s55, s60
    s_sub_u32 s55, s55, 768
    buffer_load_dwordx4 v[232:235], v10, s[40:43], s55 offen sc1
    buffer_load_dwordx4 v[236:239], v19, s[40:43], s55 offen sc1
    v_mfma_f32_16x16x32_bf16 v[64:67], v[96:99], v[212:215], v[64:67]
    v_mfma_f32_16x16x32_bf16 v[72:75], v[104:107], v[212:215], v[72:75]
    ds_read_b64_tr_b16 v[112:113], v14 offset:0
    ds_read_b64_tr_b16 v[114:115], v14 offset:1024
    ds_read_b64_tr_b16 v[116:117], v18 offset:0
    ds_read_b64_tr_b16 v[118:119], v18 offset:1024
    v_mfma_f32_16x16x32_bf16 v[48:51], v[100:103], v[208:211], v[48:51]
    s_waitcnt lgkmcnt(4)
    v_mfma_f32_16x16x32_bf16 v[56:59], v[108:111], v[208:211], v[56:59]
    s_add_u32 m0, s54, 8224
    s_add_u32 s57, s57, 1
    s_and_b32 s57, s57, 15
    s_lshl_b32 s56, s57, 14
    s_add_u32 s56, s56, s58
    buffer_load_dwordx4 v1, s[24:27], s56 offen lds
    buffer_load_dwordx4 v2, s[24:27], s56 offen offset:1024 lds
    v_mfma_f32_16x16x32_bf16 v[80:83], v[100:103], v[212:215], v[80:83]
    v_mfma_f32_16x16x32_bf16 v[88:91], v[108:111], v[212:215], v[88:91]
    s_waitcnt vmcnt(10)
    v_mfma_f32_16x16x32_bf16 v[36:39], v[96:99], v[216:219], v[36:39]
    v_mfma_f32_16x16x32_bf16 v[44:47], v[104:107], v[216:219], v[44:47]
    s_add_u32 s59, s59, 1
    s_and_b32 s59, s59, 15
    s_lshl_b32 s55, s59, 10
    s_add_u32 s55, s55, s60
    buffer_load_dwordx4 v[240:243], v10, s[40:43], s55 offen sc1
    buffer_load_dwordx4 v[244:247], v19, s[40:43], s55 offen sc1
    v_mfma_f32_16x16x32_bf16 v[68:71], v[96:99], v[220:223], v[68:71]
    v_mfma_f32_16x16x32_bf16 v[76:79], v[104:107], v[220:223], v[76:79]
    ds_read_b64_tr_b16 v[120:121], v14 offset:16
    ds_read_b64_tr_b16 v[122:123], v14 offset:1040
    ds_read_b64_tr_b16 v[124:125], v18 offset:16
    ds_read_b64_tr_b16 v[126:127], v18 offset:1040
    v_mfma_f32_16x16x32_bf16 v[52:55], v[100:103], v[216:219], v[52:55]
    v_mfma_f32_16x16x32_bf16 v[60:63], v[108:111], v[216:219], v[60:63]
    s_add_u32 m0, s54, 10288
    s_add_u32 s57, s57, 1
    s_and_b32 s57, s57, 15
    s_lshl_b32 s56, s57, 14
    s_add_u32 s56, s56, s58
    buffer_load_dwordx4 v1, s[24:27], s56 offen lds
    buffer_load_dwordx4 v2, s[24:27], s56 offen offset:1024 lds
    v_mfma_f32_16x16x32_bf16 v[84:87], v[100:103], v[220:223], v[84:87]
    v_mfma_f32_16x16x32_bf16 v[92:95], v[108:111], v[220:223], v[92:95]
    s_waitcnt vmcnt(10)
    s_waitcnt lgkmcnt(6)
    v_mfma_f32_16x16x32_bf16 v[32:35], v[112:115], v[224:227], v[32:35]
    s_waitcnt lgkmcnt(2)
    v_mfma_f32_16x16x32_bf16 v[40:43], v[120:123], v[224:227], v[40:43]
    s_add_u32 s59, s59, 1
    s_and_b32 s59, s59, 15
    s_lshl_b32 s55, s59, 10
    s_add_u32 s55, s55, s60
    s_sub_u32 s55, s55, 768
    buffer_load_dwordx4 v[248:251], v10, s[40:43], s55 offen sc1
    buffer_load_dwordx4 v[252:255], v19, s[40:43], s55 offen sc1
    v_mfma_f32_16x16x32_bf16 v[64:67], v[112:115], v[228:231], v[64:67]
    v_mfma_f32_16x16x32_bf16 v[72:75], v[120:123], v[228:231], v[72:75]
    ds_read_b64_tr_b16 v[96:97], v11 offset:0
    ds_read_b64_tr_b16 v[98:99], v11 offset:1024
    ds_read_b64_tr_b16 v[100:101], v12 offset:0
    ds_read_b64_tr_b16 v[102:103], v12 offset:1024
    v_mfma_f32_16x16x32_bf16 v[48:51], v[116:119], v[224:227], v[48:51]
    s_waitcnt lgkmcnt(4)
    v_mfma_f32_16x16x32_bf16 v[56:59], v[124:127], v[224:227], v[56:59]
    s_add_u32 m0, s4, 0
    s_add_u32 s57, s57, 1
    s_and_b32 s57, s57, 15
    s_lshl_b32 s56, s57, 14
    s_add_u32 s56, s56, s58
    buffer_load_dwordx4 v1, s[24:27], s56 offen lds
    buffer_load_dwordx4 v2, s[24:27], s56 offen offset:1024 lds
    v_mfma_f32_16x16x32_bf16 v[80:83], v[116:119], v[228:231], v[80:83]
    v_mfma_f32_16x16x32_bf16 v[88:91], v[124:127], v[228:231], v[88:91]
    s_waitcnt vmcnt(10)
    v_mfma_f32_16x16x32_bf16 v[36:39], v[112:115], v[232:235], v[36:39]
    v_mfma_f32_16x16x32_bf16 v[44:47], v[120:123], v[232:235], v[44:47]
    s_add_u32 s59, s59, 1
    s_and_b32 s59, s59, 15
    s_lshl_b32 s55, s59, 10
    s_add_u32 s55, s55, s60
    buffer_load_dwordx4 v[176:179], v10, s[40:43], s55 offen sc1
    buffer_load_dwordx4 v[180:183], v19, s[40:43], s55 offen sc1
    v_mfma_f32_16x16x32_bf16 v[68:71], v[112:115], v[236:239], v[68:71]
    v_mfma_f32_16x16x32_bf16 v[76:79], v[120:123], v[236:239], v[76:79]
    ds_read_b64_tr_b16 v[104:105], v11 offset:16
    ds_read_b64_tr_b16 v[106:107], v11 offset:1040
    ds_read_b64_tr_b16 v[108:109], v12 offset:16
    ds_read_b64_tr_b16 v[110:111], v12 offset:1040
    v_mfma_f32_16x16x32_bf16 v[52:55], v[116:119], v[232:235], v[52:55]
    v_mfma_f32_16x16x32_bf16 v[60:63], v[124:127], v[232:235], v[60:63]
    s_add_u32 m0, s4, 2064
    s_add_u32 s57, s57, 1
    s_and_b32 s57, s57, 15
    s_lshl_b32 s56, s57, 14
    s_add_u32 s56, s56, s58
    buffer_load_dwordx4 v1, s[24:27], s56 offen lds
    buffer_load_dwordx4 v2, s[24:27], s56 offen offset:1024 lds
    v_mfma_f32_16x16x32_bf16 v[84:87], v[116:119], v[236:239], v[84:87]
    v_mfma_f32_16x16x32_bf16 v[92:95], v[124:127], v[236:239], v[92:95]
    s_waitcnt vmcnt(10)
    s_waitcnt lgkmcnt(6)
    v_mfma_f32_16x16x32_bf16 v[32:35], v[96:99], v[240:243], v[32:35]
    s_waitcnt lgkmcnt(2)
    v_mfma_f32_16x16x32_bf16 v[40:43], v[104:107], v[240:243], v[40:43]
    s_add_u32 s59, s59, 1
    s_and_b32 s59, s59, 15
    s_lshl_b32 s55, s59, 10
    s_add_u32 s55, s55, s60
    s_sub_u32 s55, s55, 768
    buffer_load_dwordx4 v[184:187], v10, s[40:43], s55 offen sc1
    buffer_load_dwordx4 v[188:191], v19, s[40:43], s55 offen sc1
    v_mfma_f32_16x16x32_bf16 v[64:67], v[96:99], v[244:247], v[64:67]
    v_mfma_f32_16x16x32_bf16 v[72:75], v[104:107], v[244:247], v[72:75]
    ds_read_b64_tr_b16 v[112:113], v11 offset:4112
    ds_read_b64_tr_b16 v[114:115], v11 offset:5136
    ds_read_b64_tr_b16 v[116:117], v12 offset:4112
    ds_read_b64_tr_b16 v[118:119], v12 offset:5136
    v_mfma_f32_16x16x32_bf16 v[48:51], v[100:103], v[240:243], v[48:51]
    s_waitcnt lgkmcnt(4)
    v_mfma_f32_16x16x32_bf16 v[56:59], v[108:111], v[240:243], v[56:59]
    s_add_u32 m0, s54, 0
    s_mul_i32 s57, s47, 10
    s_sub_u32 s57, 64, s57
    s_lshl_b32 s56, s57, 14
    s_add_u32 s56, s56, s58
    buffer_load_dwordx4 v1, s[24:27], s56 offen lds
    buffer_load_dwordx4 v2, s[24:27], s56 offen offset:1024 lds
    v_mfma_f32_16x16x32_bf16 v[80:83], v[100:103], v[244:247], v[80:83]
    v_mfma_f32_16x16x32_bf16 v[88:91], v[108:111], v[244:247], v[88:91]
    s_waitcnt vmcnt(10)
    v_mfma_f32_16x16x32_bf16 v[36:39], v[96:99], v[248:251], v[36:39]
    v_mfma_f32_16x16x32_bf16 v[44:47], v[104:107], v[248:251], v[44:47]
    s_add_u32 s59, s59, 1
    s_and_b32 s59, s59, 15
    s_lshl_b32 s55, s59, 10
    s_add_u32 s55, s55, s60
    buffer_load_dwordx4 v[192:195], v10, s[40:43], s55 offen sc1
    buffer_load_dwordx4 v[196:199], v19, s[40:43], s55 offen sc1
    v_mfma_f32_16x16x32_bf16 v[68:71], v[96:99], v[252:255], v[68:71]
    v_mfma_f32_16x16x32_bf16 v[76:79], v[104:107], v[252:255], v[76:79]
    ds_read_b64_tr_b16 v[120:121], v11 offset:4128
    ds_read_b64_tr_b16 v[122:123], v11 offset:5152
    ds_read_b64_tr_b16 v[124:125], v12 offset:4128
    ds_read_b64_tr_b16 v[126:127], v12 offset:5152
    v_mfma_f32_16x16x32_bf16 v[52:55], v[100:103], v[248:251], v[52:55]
    v_mfma_f32_16x16x32_bf16 v[60:63], v[108:111], v[248:251], v[60:63]
    s_add_u32 m0, s54, 2064
    s_add_u32 s57, s57, 1
    s_lshl_b32 s56, s57, 14
    s_add_u32 s56, s56, s58
    buffer_load_dwordx4 v1, s[24:27], s56 offen lds
    buffer_load_dwordx4 v2, s[24:27], s56 offen offset:1024 lds
    v_mfma_f32_16x16x32_bf16 v[84:87], v[100:103], v[252:255], v[84:87]
    v_mfma_f32_16x16x32_bf16 v[92:95], v[108:111], v[252:255], v[92:95]
    s_waitcnt vmcnt(10)
    s_waitcnt lgkmcnt(6)
    v_mfma_f32_16x16x32_bf16 v[32:35], v[112:115], v[176:179], v[32:35]
    s_waitcnt lgkmcnt(2)
    v_mfma_f32_16x16x32_bf16 v[40:43], v[120:123], v[176:179], v[40:43]
    s_add_u32 s59, s59, 1
    s_and_b32 s59, s59, 15
    s_lshl_b32 s55, s59, 10
    s_add_u32 s55, s55, s60
    s_sub_u32 s55, s55, 768
    buffer_load_dwordx4 v[200:203], v10, s[40:43], s55 offen sc1
    buffer_load_dwordx4 v[204:207], v19, s[40:43], s55 offen sc1
    v_mfma_f32_16x16x32_bf16 v[64:67], v[112:115], v[180:183], v[64:67]
    v_mfma_f32_16x16x32_bf16 v[72:75], v[120:123], v[180:183], v[72:75]
    ds_read_b64_tr_b16 v[96:97], v11 offset:8224
    ds_read_b64_tr_b16 v[98:99], v11 offset:9248
    ds_read_b64_tr_b16 v[100:101], v12 offset:8224
    ds_read_b64_tr_b16 v[102:103], v12 offset:9248
    v_mfma_f32_16x16x32_bf16 v[48:51], v[116:119], v[176:179], v[48:51]
    s_waitcnt lgkmcnt(4)
    v_mfma_f32_16x16x32_bf16 v[56:59], v[124:127], v[176:179], v[56:59]
    s_add_u32 m0, s54, 4112
    s_add_u32 s57, s57, 1
    s_lshl_b32 s56, s57, 14
    s_add_u32 s56, s56, s58
    buffer_load_dwordx4 v1, s[24:27], s56 offen lds
    buffer_load_dwordx4 v2, s[24:27], s56 offen offset:1024 lds
    v_mfma_f32_16x16x32_bf16 v[80:83], v[116:119], v[180:183], v[80:83]
    v_mfma_f32_16x16x32_bf16 v[88:91], v[124:127], v[180:183], v[88:91]
    s_add_u32 s64, s64, 49152
    s_cmp_eq_u32 s47, 3
    s_cselect_b32 s65, 6, 8
    s_mov_b32 s69, 0
    s_atomic_add s69, s[40:41], s64 glc
    s_waitcnt vmcnt(10)
    v_mfma_f32_16x16x32_bf16 v[36:39], v[112:115], v[184:187], v[36:39]
    v_mfma_f32_16x16x32_bf16 v[44:47], v[120:123], v[184:187], v[44:47]
    s_add_u32 s59, s59, 1
    s_and_b32 s59, s59, 15
    s_lshl_b32 s55, s59, 10
    s_add_u32 s55, s55, s60
    buffer_load_dwordx4 v[208:211], v10, s[40:43], s55 offen sc1
    buffer_load_dwordx4 v[212:215], v19, s[40:43], s55 offen sc1
    v_mfma_f32_16x16x32_bf16 v[68:71], v[112:115], v[188:191], v[68:71]
    v_mfma_f32_16x16x32_bf16 v[76:79], v[120:123], v[188:191], v[76:79]
    ds_read_b64_tr_b16 v[104:105], v11 offset:8240
    ds_read_b64_tr_b16 v[106:107], v11 offset:9264
    ds_read_b64_tr_b16 v[108:109], v12 offset:8240
    ds_read_b64_tr_b16 v[110:111], v12 offset:9264
    v_mfma_f32_16x16x32_bf16 v[52:55], v[116:119], v[184:187], v[52:55]
    v_mfma_f32_16x16x32_bf16 v[60:63], v[124:127], v[184:187], v[60:63]
    s_add_u32 m0, s54, 6176
    s_add_u32 s57, s57, 1
    s_lshl_b32 s56, s57, 14
    s_add_u32 s56, s56, s58
    buffer_load_dwordx4 v1, s[24:27], s56 offen lds
    buffer_load_dwordx4 v2, s[24:27], s56 offen offset:1024 lds
    v_mfma_f32_16x16x32_bf16 v[84:87], v[116:119], v[188:191], v[84:87]
    v_mfma_f32_16x16x32_bf16 v[92:95], v[124:127], v[188:191], v[92:95]
    s_waitcnt vmcnt(10)
    s_waitcnt lgkmcnt(6)
    v_mfma_f32_16x16x32_bf16 v[32:35], v[96:99], v[192:195], v[32:35]
    s_waitcnt lgkmcnt(2)
    v_mfma_f32_16x16x32_bf16 v[40:43], v[104:107], v[192:195], v[40:43]
    s_add_u32 s59, s59, 1
    s_and_b32 s59, s59, 15
    s_lshl_b32 s55, s59, 10
    s_add_u32 s55, s55, s60
    s_sub_u32 s55, s55, 768
    buffer_load_dwordx4 v[216:219], v10, s[40:43], s55 offen sc1
    buffer_load_dwordx4 v[220:223], v19, s[40:43], s55 offen sc1
    v_mfma_f32_16x16x32_bf16 v[64:67], v[96:99], v[196:199], v[64:67]
    v_mfma_f32_16x16x32_bf16 v[72:75], v[104:107], v[196:199], v[72:75]
    ds_read_b64_tr_b16 v[112:113], v14 offset:0
    ds_read_b64_tr_b16 v[114:115], v14 offset:1024
    ds_read_b64_tr_b16 v[116:117], v18 offset:0
    ds_read_b64_tr_b16 v[118:119], v18 offset:1024
    v_mfma_f32_16x16x32_bf16 v[48:51], v[100:103], v[192:195], v[48:51]
    s_waitcnt lgkmcnt(4)
    v_mfma_f32_16x16x32_bf16 v[56:59], v[108:111], v[192:195], v[56:59]
    s_add_u32 m0, s54, 8224
    s_add_u32 s57, s57, 1
    s_lshl_b32 s56, s57, 14
    s_add_u32 s56, s56, s58
    buffer_load_dwordx4 v1, s[24:27], s56 offen lds
    buffer_load_dwordx4 v2, s[24:27], s56 offen offset:1024 lds
    v_mfma_f32_16x16x32_bf16 v[80:83], v[100:103], v[196:199], v[80:83]
    v_mfma_f32_16x16x32_bf16 v[88:91], v[108:111], v[196:199], v[88:91]
    s_waitcnt vmcnt(10)
    v_mfma_f32_16x16x32_bf16 v[36:39], v[96:99], v[200:203], v[36:39]
    v_mfma_f32_16x16x32_bf16 v[44:47], v[104:107], v[200:203], v[44:47]
    s_waitcnt lgkmcnt(0)
    s_cmp_ge_u32 s69, s65
    s_cbranch_scc1 L_hready_49
    s_mov_b32 s70, 200000
L_spoll_50:
    s_mov_b32 s69, 0
    s_atomic_add s69, s[40:41], s64 glc
    s_waitcnt lgkmcnt(0)
    s_cmp_ge_u32 s69, s65
    s_cbranch_scc1 L_sdone_51
    s_sub_u32 s70, s70, 1
    s_cmp_lg_u32 s70, 0
    s_cbranch_scc1 L_spoll_50
L_sdone_51:
L_hready_49:
    s_lshl_b32 s64, s49, 1
    s_and_b32 s55, s47, 1
    s_add_u32 s64, s64, s55
    s_lshl_b32 s64, s64, 7
    s_add_u32 s64, s64, 12320768
    buffer_load_dword v17, v17, s[40:43], s64 offen sc1
    s_mul_i32 s59, s47, 10
    s_sub_u32 s59, 64, s59
    s_lshl_b32 s55, s59, 10
    s_add_u32 s55, s55, s60
    buffer_load_dwordx4 v[224:227], v10, s[40:43], s55 offen sc1
    buffer_load_dwordx4 v[228:231], v19, s[40:43], s55 offen sc1
    v_mfma_f32_16x16x32_bf16 v[68:71], v[96:99], v[204:207], v[68:71]
    v_mfma_f32_16x16x32_bf16 v[76:79], v[104:107], v[204:207], v[76:79]
    ds_read_b64_tr_b16 v[120:121], v14 offset:16
    ds_read_b64_tr_b16 v[122:123], v14 offset:1040
    ds_read_b64_tr_b16 v[124:125], v18 offset:16
    ds_read_b64_tr_b16 v[126:127], v18 offset:1040
    v_mfma_f32_16x16x32_bf16 v[52:55], v[100:103], v[200:203], v[52:55]
    v_mfma_f32_16x16x32_bf16 v[60:63], v[108:111], v[200:203], v[60:63]
    s_add_u32 m0, s54, 10288
    s_add_u32 s57, s57, 1
    s_lshl_b32 s56, s57, 14
    s_add_u32 s56, s56, s58
    buffer_load_dwordx4 v1, s[24:27], s56 offen lds
    buffer_load_dwordx4 v2, s[24:27], s56 offen offset:1024 lds
    v_mfma_f32_16x16x32_bf16 v[84:87], v[100:103], v[204:207], v[84:87]
    v_mfma_f32_16x16x32_bf16 v[92:95], v[108:111], v[204:207], v[92:95]
    s_and_b32 s9, s47, 1
    s_lshr_b32 s10, s47, 1
    s_lshl_b32 s5, s49, 1
    s_add_u32 s5, s5, s9
    s_lshl_b32 s5, s5, 1
    s_add_u32 s5, s5, s10
    s_lshl_b32 s5, s5, 8
    s_add_u32 s5, s5, 12615680
    s_add_u32 s11, s5, 128
    s_mov_b32 s69, 0
    s_mov_b32 s8, 0
    s_atomic_add s69, s[40:41], s5 glc
    s_atomic_add s8, s[40:41], s11 glc
    s_lshl_b32 s6, s49, 1
    s_add_u32 s6, s6, s9
    s_lshl_b32 s7, s6, 5
    s_lshl_b32 s66, s10, 4
    s_add_u32 s7, s7, s66
    s_lshl_b32 s7, s7, 10
    s_add_u32 s7, s7, 4194304
    s_lshl_b32 s6, s6, 15
    s_lshl_b32 s66, s50, 7
    s_add_u32 s6, s6, s66
    s_lshl_b32 s66, s10, 6
    s_add_u32 s6, s6, s66
    s_waitcnt vmcnt(11)
    v_mfma_f32_16x16x32_bf16 v[32:35], v[112:115], v[208:211], v[32:35]
    s_waitcnt lgkmcnt(2)
    v_mfma_f32_16x16x32_bf16 v[40:43], v[120:123], v[208:211], v[40:43]
    s_add_u32 s59, s59, 1
    s_lshl_b32 s55, s59, 10
    s_add_u32 s55, s55, s60
    s_sub_u32 s55, s55, 768
    buffer_load_dwordx4 v[232:235], v10, s[40:43], s55 offen sc1
    buffer_load_dwordx4 v[236:239], v19, s[40:43], s55 offen sc1
    v_mfma_f32_16x16x32_bf16 v[64:67], v[112:115], v[212:215], v[64:67]
    v_mfma_f32_16x16x32_bf16 v[72:75], v[120:123], v[212:215], v[72:75]
    ds_read_b64_tr_b16 v[128:129], v11 offset:0
    ds_read_b64_tr_b16 v[130:131], v11 offset:1024
    ds_read_b64_tr_b16 v[132:133], v12 offset:0
    ds_read_b64_tr_b16 v[134:135], v12 offset:1024
    v_mfma_f32_16x16x32_bf16 v[48:51], v[116:119], v[208:211], v[48:51]
    s_waitcnt lgkmcnt(4)
    v_mfma_f32_16x16x32_bf16 v[56:59], v[124:127], v[208:211], v[56:59]
    s_add_u32 s59, s59, 1
    s_lshl_b32 s55, s59, 10
    s_add_u32 s55, s55, s60
    buffer_load_dwordx4 v[240:243], v10, s[40:43], s55 offen sc1
    buffer_load_dwordx4 v[244:247], v19, s[40:43], s55 offen sc1
    v_mfma_f32_16x16x32_bf16 v[80:83], v[116:119], v[212:215], v[80:83]
    v_mfma_f32_16x16x32_bf16 v[88:91], v[124:127], v[212:215], v[88:91]
    s_waitcnt vmcnt(13)
    ds_read_b64_tr_b16 v[144:145], v11 offset:4112
    ds_read_b64_tr_b16 v[146:147], v11 offset:5136
    ds_read_b64_tr_b16 v[148:149], v12 offset:4112
    ds_read_b64_tr_b16 v[150:151], v12 offset:5136
    s_waitcnt vmcnt(11)
    v_mfma_f32_16x16x32_bf16 v[36:39], v[112:115], v[216:219], v[36:39]
    v_mfma_f32_16x16x32_bf16 v[44:47], v[120:123], v[216:219], v[44:47]
    s_add_u32 s59, s59, 1
    s_lshl_b32 s55, s59, 10
    s_add_u32 s55, s55, s60
    s_sub_u32 s55, s55, 768
    buffer_load_dwordx4 v[248:251], v10, s[40:43], s55 offen sc1
    buffer_load_dwordx4 v[252:255], v19, s[40:43], s55 offen sc1
    v_mfma_f32_16x16x32_bf16 v[68:71], v[112:115], v[220:223], v[68:71]
    v_mfma_f32_16x16x32_bf16 v[76:79], v[120:123], v[220:223], v[76:79]
    ds_read_b64_tr_b16 v[136:137], v11 offset:16
    ds_read_b64_tr_b16 v[138:139], v11 offset:1040
    ds_read_b64_tr_b16 v[140:141], v12 offset:16
    ds_read_b64_tr_b16 v[142:143], v12 offset:1040
    v_mfma_f32_16x16x32_bf16 v[52:55], v[116:119], v[216:219], v[52:55]
    v_mfma_f32_16x16x32_bf16 v[60:63], v[124:127], v[216:219], v[60:63]
    s_add_u32 s59, s59, 1
    s_lshl_b32 s55, s59, 10
    s_add_u32 s55, s55, s60
    s_cmp_eq_u32 s47, 3
    s_cselect_b32 s55, 536870912, s55
    buffer_load_dwordx4 v[176:179], v10, s[40:43], s55 offen sc1
    buffer_load_dwordx4 v[180:183], v19, s[40:43], s55 offen sc1
    v_mfma_f32_16x16x32_bf16 v[84:87], v[116:119], v[220:223], v[84:87]
    v_mfma_f32_16x16x32_bf16 v[92:95], v[124:127], v[220:223], v[92:95]
    ds_read_b64_tr_b16 v[152:153], v11 offset:4128
    ds_read_b64_tr_b16 v[154:155], v11 offset:5152
    ds_read_b64_tr_b16 v[156:157], v12 offset:4128
    ds_read_b64_tr_b16 v[158:159], v12 offset:5152
    s_add_u32 s59, s59, 1
    s_lshl_b32 s55, s59, 10
    s_add_u32 s55, s55, s60
    s_sub_u32 s55, s55, 768
    s_cmp_eq_u32 s47, 3
    s_cselect_b32 s55, 536870912, s55
    buffer_load_dwordx4 v[184:187], v10, s[40:43], s55 offen sc1
    buffer_load_dwordx4 v[188:191], v19, s[40:43], s55 offen sc1
    s_waitcnt vmcnt(10)
    ds_read_b64_tr_b16 v[160:161], v11 offset:8224
    ds_read_b64_tr_b16 v[162:163], v11 offset:9248
    ds_read_b64_tr_b16 v[164:165], v12 offset:8224
    ds_read_b64_tr_b16 v[166:167], v12 offset:9248
    ds_read_b64_tr_b16 v[168:169], v11 offset:8240
    ds_read_b64_tr_b16 v[170:171], v11 offset:9264
    ds_read_b64_tr_b16 v[172:173], v12 offset:8240
    ds_read_b64_tr_b16 v[174:175], v12 offset:9264
    ds_read_b32 v7, v13 offset:32
    s_waitcnt lgkmcnt(0)
    v_cmp_gt_u32 vcc, 1, v7
    s_cbranch_vccz L_ldone_53
    s_mov_b32 s70, 1000000
L_lspin_52:
    s_sleep 2
    ds_read_b32 v7, v13 offset:32
    s_waitcnt lgkmcnt(0)
    v_cmp_gt_u32 vcc, 1, v7
    s_cbranch_vccz L_ldone_53
    s_sub_u32 s70, s70, 1
    s_cmp_lg_u32 s70, 0
    s_cbranch_scc1 L_lspin_52
L_ldone_53:
    s_mov_b32 s69, 0
    s_mov_b32 s8, 0
    s_atomic_add s69, s[40:41], s5 glc
    s_atomic_add s8, s[40:41], s11 glc
    v_mfma_f32_16x16x32_bf16 v[64:67], v[128:131], v[228:231], v[64:67]
    v_mfma_f32_16x16x32_bf16 v[72:75], v[136:139], v[228:231], v[72:75]
    s_waitcnt vmcnt(8)
    v_mfma_f32_16x16x32_bf16 v[68:71], v[128:131], v[236:239], v[68:71]
    v_mfma_f32_16x16x32_bf16 v[76:79], v[136:139], v[236:239], v[76:79]
    s_waitcnt vmcnt(6)
    v_mfma_f32_16x16x32_bf16 v[64:67], v[144:147], v[244:247], v[64:67]
    v_mfma_f32_16x16x32_bf16 v[72:75], v[152:155], v[244:247], v[72:75]
    s_waitcnt vmcnt(4)
    v_mfma_f32_16x16x32_bf16 v[68:71], v[144:147], v[252:255], v[68:71]
    v_mfma_f32_16x16x32_bf16 v[76:79], v[152:155], v[252:255], v[76:79]
    s_waitcnt vmcnt(2)
    v_mfma_f32_16x16x32_bf16 v[64:67], v[160:163], v[180:183], v[64:67]
    v_mfma_f32_16x16x32_bf16 v[72:75], v[168:171], v[180:183], v[72:75]
    s_waitcnt vmcnt(0)
    v_mfma_f32_16x16x32_bf16 v[68:71], v[160:163], v[188:191], v[68:71]
    v_mfma_f32_16x16x32_bf16 v[76:79], v[168:171], v[188:191], v[76:79]
    v_mfma_f32_16x16x32_bf16 v[48:51], v[132:135], v[224:227], v[48:51]
    v_mfma_f32_16x16x32_bf16 v[56:59], v[140:143], v[224:227], v[56:59]
    s_waitcnt vmcnt(0)
    s_waitcnt lgkmcnt(0)
    s_cmp_lt_u32 s69, 8
    s_cselect_b32 s66, 1, 0
    s_lshl_b32 s68, s66, 13
    s_add_u32 s55, s7, s68
    s_add_u32 s68, s55, 4096
    s_max_u32 s67, s69, s8
    s_lshr_b32 s67, s67, 3
    v_mfma_f32_16x16x32_bf16 v[52:55], v[132:135], v[232:235], v[52:55]
    v_mfma_f32_16x16x32_bf16 v[60:63], v[140:143], v[232:235], v[60:63]
    s_cbranch_scc0 L_noearly_54
    buffer_load_dwordx4 v[96:99], v16, s[40:43], s55 offen offset:0 sc1
L_noearly_54:
    v_mfma_f32_16x16x32_bf16 v[48:51], v[148:151], v[240:243], v[48:51]
    ds_write_b128 v15, v[64:67] offset:4096
    v_mfma_f32_16x16x32_bf16 v[56:59], v[156:159], v[240:243], v[56:59]
    s_cbranch_scc0 L_noearly_55
    buffer_load_dwordx4 v[100:103], v16, s[40:43], s55 offen offset:1024 sc1
L_noearly_55:
    v_mfma_f32_16x16x32_bf16 v[52:55], v[148:151], v[248:251], v[52:55]
    ds_write_b128 v15, v[68:71] offset:5120
    v_mfma_f32_16x16x32_bf16 v[60:63], v[156:159], v[248:251], v[60:63]
    s_cbranch_scc0 L_noearly_56
    buffer_load_dwordx4 v[104:107], v16, s[40:43], s55 offen offset:2048 sc1
L_noearly_56:
    v_mfma_f32_16x16x32_bf16 v[48:51], v[164:167], v[176:179], v[48:51]
    ds_write_b128 v15, v[72:75] offset:6144
    v_mfma_f32_16x16x32_bf16 v[56:59], v[172:175], v[176:179], v[56:59]
    s_cbranch_scc0 L_noearly_57
    buffer_load_dwordx4 v[108:111], v16, s[40:43], s55 offen offset:3072 sc1
L_noearly_57:
    v_mfma_f32_16x16x32_bf16 v[52:55], v[164:167], v[184:187], v[52:55]
    ds_write_b128 v15, v[76:79] offset:7168
    v_mfma_f32_16x16x32_bf16 v[60:63], v[172:175], v[184:187], v[60:63]
    s_cbranch_scc0 L_noearly_58
    buffer_load_dwordx4 v[112:115], v16, s[40:43], s68 offen offset:0 sc1
L_noearly_58:
    v_mfma_f32_16x16x32_bf16 v[80:83], v[132:135], v[228:231], v[80:83]
    v_mfma_f32_16x16x32_bf16 v[88:91], v[140:143], v[228:231], v[88:91]
    s_cbranch_scc0 L_noearly_59
    buffer_load_dwordx4 v[116:119], v16, s[40:43], s68 offen offset:1024 sc1
L_noearly_59:
    v_mfma_f32_16x16x32_bf16 v[84:87], v[132:135], v[236:239], v[84:87]
    v_mfma_f32_16x16x32_bf16 v[92:95], v[140:143], v[236:239], v[92:95]
    s_cbranch_scc0 L_noearly_60
    buffer_load_dwordx4 v[120:123], v16, s[40:43], s68 offen offset:2048 sc1
L_noearly_60:
    v_mfma_f32_16x16x32_bf16 v[80:83], v[148:151], v[244:247], v[80:83]
    s_nop 2
    ds_write_b128 v15, v[48:51] offset:0
    v_mfma_f32_16x16x32_bf16 v[88:91], v[156:159], v[244:247], v[88:91]
    s_cbranch_scc0 L_noearly_61
    buffer_load_dwordx4 v[124:127], v16, s[40:43], s68 offen offset:3072 sc1
L_noearly_61:
    v_mfma_f32_16x16x32_bf16 v[84:87], v[148:151], v[252:255], v[84:87]
    ds_write_b128 v15, v[52:55] offset:1024
    v_mfma_f32_16x16x32_bf16 v[92:95], v[156:159], v[252:255], v[92:95]
    v_mfma_f32_16x16x32_bf16 v[80:83], v[164:167], v[180:183], v[80:83]
    ds_write_b128 v15, v[56:59] offset:2048
    v_mfma_f32_16x16x32_bf16 v[88:91], v[172:175], v[180:183], v[88:91]
    s_mov_b32 s69, 0
    s_mov_b32 s8, 0
    s_atomic_add s69, s[40:41], s5 glc
    s_atomic_add s8, s[40:41], s11 glc
    v_mfma_f32_16x16x32_bf16 v[84:87], v[164:167], v[188:191], v[84:87]
    ds_write_b128 v15, v[60:63] offset:3072
    v_mfma_f32_16x16x32_bf16 v[92:95], v[172:175], v[188:191], v[92:95]
    v_mfma_f32_16x16x32_bf16 v[32:35], v[128:131], v[224:227], v[32:35]
    v_mfma_f32_16x16x32_bf16 v[40:43], v[136:139], v[224:227], v[40:43]
    v_mfma_f32_16x16x32_bf16 v[36:39], v[128:131], v[232:235], v[36:39]
    v_mfma_f32_16x16x32_bf16 v[44:47], v[136:139], v[232:235], v[44:47]
    v_mfma_f32_16x16x32_bf16 v[32:35], v[144:147], v[240:243], v[32:35]
    s_nop 2
    ds_write_b128 v15, v[80:83] offset:8192
    v_mfma_f32_16x16x32_bf16 v[40:43], v[152:155], v[240:243], v[40:43]
    v_mfma_f32_16x16x32_bf16 v[36:39], v[144:147], v[248:251], v[36:39]
    ds_write_b128 v15, v[84:87] offset:9216
    v_mfma_f32_16x16x32_bf16 v[44:47], v[152:155], v[248:251], v[44:47]
    v_mfma_f32_16x16x32_bf16 v[32:35], v[160:163], v[176:179], v[32:35]
    ds_write_b128 v15, v[88:91] offset:10240
    v_mfma_f32_16x16x32_bf16 v[40:43], v[168:171], v[176:179], v[40:43]
    v_mfma_f32_16x16x32_bf16 v[36:39], v[160:163], v[184:187], v[36:39]
    ds_write_b128 v15, v[92:95] offset:11264
    v_mfma_f32_16x16x32_bf16 v[44:47], v[168:171], v[184:187], v[44:47]
    s_mov_b64 exec, 1
    ds_add_u32 v5, v6 offset:4
    s_mov_b64 exec, -1
    s_cmp_lg_u32 s67, 0
    s_cbranch_scc1 L_oloaded_64
    s_mov_b32 s70, 200000
L_opoll_62:
    s_waitcnt lgkmcnt(0)
    s_max_u32 s67, s69, s8
    s_cmp_ge_u32 s67, 8
    s_cbranch_scc1 L_ogot_63
    s_mov_b32 s69, 0
    s_mov_b32 s8, 0
    s_atomic_add s69, s[40:41], s5 glc
    s_atomic_add s8, s[40:41], s11 glc
    s_sub_u32 s70, s70, 1
    s_cbranch_scc0 L_opoll_62
    s_waitcnt lgkmcnt(0)
L_ogot_63:
    s_cmp_lt_u32 s69, 8
    s_cselect_b32 s66, 1, 0
    s_lshl_b32 s68, s66, 13
    s_add_u32 s55, s7, s68
    s_add_u32 s68, s55, 4096
    buffer_load_dwordx4 v[96:99], v16, s[40:43], s55 offen offset:0 sc1
    buffer_load_dwordx4 v[100:103], v16, s[40:43], s55 offen offset:1024 sc1
    buffer_load_dwordx4 v[104:107], v16, s[40:43], s55 offen offset:2048 sc1
    buffer_load_dwordx4 v[108:111], v16, s[40:43], s55 offen offset:3072 sc1
    buffer_load_dwordx4 v[112:115], v16, s[40:43], s68 offen offset:0 sc1
    buffer_load_dwordx4 v[116:119], v16, s[40:43], s68 offen offset:1024 sc1
    buffer_load_dwordx4 v[120:123], v16, s[40:43], s68 offen offset:2048 sc1
    buffer_load_dwordx4 v[124:127], v16, s[40:43], s68 offen offset:3072 sc1
    s_mov_b32 s69, 0
    s_mov_b32 s8, 0
    s_atomic_add s69, s[40:41], s5 glc
    s_atomic_add s8, s[40:41], s11 glc
L_oloaded_64:
    s_xor_b32 s7, s55, 0x2000
    s_xor_b32 s11, s66, 1
    s_lshl_b32 s11, s11, 7
    s_add_u32 s11, s11, s5
    s_lshl_b32 s68, s10, 1
    s_add_u32 s66, s66, s68
    s_lshl_b32 s68, s66, 14
    s_add_u32 s68, s68, 74240
    v_add_u32 v11, s68, v9
    s_xor_b32 s66, s66, 1
    s_lshl_b32 s68, s66, 14
    s_add_u32 s68, s68, 74240
    v_add_u32 v14, s68, v9
    v_xor_b32 v12, 64, v11
    v_xor_b32 v18, 64, v14
    ds_read_b32 v7, v5 offset:4
    ds_read_b64_tr_b16 v[184:185], v11 offset:0
    ds_read_b64_tr_b16 v[186:187], v11 offset:1024
    ds_read_b64_tr_b16 v[188:189], v12 offset:0
    ds_read_b64_tr_b16 v[190:191], v12 offset:1024
    ds_read_b64_tr_b16 v[192:193], v11 offset:2048
    ds_read_b64_tr_b16 v[194:195], v11 offset:3072
    ds_read_b64_tr_b16 v[196:197], v12 offset:2048
    ds_read_b64_tr_b16 v[198:199], v12 offset:3072
    v_mul_f32 v2, 0x3fb8aa3b, v17
    v_exp_f32 v4, v2
    v_exp_f32 v2, -v2
    s_nop 0
    v_add_f32 v4, 1.0, v4
    v_add_f32 v2, 1.0, v2
    v_rcp_f32 v4, v4
    v_rcp_f32 v2, v2
    s_waitcnt lgkmcnt(8)
    v_cmp_gt_u32 vcc, 16, v7
    s_cbranch_vccz L_ldone_67
    s_mov_b32 s70, 1000000
L_lspin_66:
    ds_read_b32 v7, v5 offset:4
    s_waitcnt lgkmcnt(0)
    v_cmp_gt_u32 vcc, 16, v7
    s_cbranch_vccz L_ldone_67
    s_sub_u32 s70, s70, 1
    s_cmp_lg_u32 s70, 0
    s_cbranch_scc1 L_lspin_66
L_ldone_67:
    s_waitcnt lgkmcnt(0)
    s_min_u32 s67, s69, s8
    s_lshr_b32 s67, s67, 3
    s_cselect_b32 s55, s7, 536870912
    s_add_u32 s68, s55, 4096
    s_waitcnt vmcnt(7)
    v_mfma_f32_32x32x16_bf16 v[168:183], v[188:191], v[96:99], 0
    ds_read_b64_tr_b16 v[208:209], v11 offset:4096
    ds_read_b64_tr_b16 v[210:211], v11 offset:5120
    ds_read_b64_tr_b16 v[212:213], v12 offset:4096
    ds_read_b64_tr_b16 v[214:215], v12 offset:5120
    buffer_load_dwordx4 v[128:131], v16, s[40:43], s55 offen offset:0 sc1
    v_mfma_f32_32x32x16_bf16 v[152:167], v[184:187], v[96:99], 0
    buffer_load_dwordx4 v[132:135], v16, s[40:43], s55 offen offset:1024 sc1
    ds_read_b128 v[48:51], v21 offset:0
    ds_read_b128 v[52:55], v21 offset:1024
    s_waitcnt vmcnt(8)
    v_mfma_f32_32x32x16_bf16 v[168:183], v[196:199], v[100:103], v[168:183]
    ds_read_b64_tr_b16 v[216:217], v11 offset:6144
    ds_read_b64_tr_b16 v[218:219], v11 offset:7168
    ds_read_b64_tr_b16 v[220:221], v12 offset:6144
    ds_read_b64_tr_b16 v[222:223], v12 offset:7168
    buffer_load_dwordx4 v[136:139], v16, s[40:43], s55 offen offset:2048 sc1
    v_mfma_f32_32x32x16_bf16 v[152:167], v[192:195], v[100:103], v[152:167]
    buffer_load_dwordx4 v[140:143], v16, s[40:43], s55 offen offset:3072 sc1
    ds_read_b128 v[56:59], v21 offset:2048
    ds_read_b128 v[60:63], v21 offset:3072
    s_mov_b32 s69, 0
    s_atomic_add s69, s[40:41], s11 glc
    s_waitcnt vmcnt(9)
    s_waitcnt lgkmcnt(6)
    v_mfma_f32_32x32x16_bf16 v[168:183], v[212:215], v[104:107], v[168:183]
    ds_read_b64_tr_b16 v[224:225], v11 offset:8192
    ds_read_b64_tr_b16 v[226:227], v11 offset:9216
    ds_read_b64_tr_b16 v[228:229], v12 offset:8192
    ds_read_b64_tr_b16 v[230:231], v12 offset:9216
    buffer_load_dwordx4 v[144:147], v16, s[40:43], s68 offen offset:0 sc1
    v_add_f32 v32, v32, v48
    v_add_f32 v33, v33, v49
    v_add_f32 v34, v34, v50
    v_add_f32 v35, v35, v51
    v_mfma_f32_32x32x16_bf16 v[152:167], v[208:211], v[104:107], v[152:167]
    buffer_load_dwordx4 v[148:151], v16, s[40:43], s68 offen offset:1024 sc1
    ds_read_b128 v[64:67], v22 offset:4096
    ds_read_b128 v[68:71], v22 offset:5120
    v_add_f32 v36, v36, v52
    v_add_f32 v37, v37, v53
    v_add_f32 v38, v38, v54
    v_add_f32 v39, v39, v55
    s_waitcnt vmcnt(10)
    s_waitcnt lgkmcnt(6)
    v_mfma_f32_32x32x16_bf16 v[168:183], v[220:223], v[108:111], v[168:183]
    ds_read_b64_tr_b16 v[232:233], v11 offset:10240
    ds_read_b64_tr_b16 v[234:235], v11 offset:11264
    ds_read_b64_tr_b16 v[236:237], v12 offset:10240
    ds_read_b64_tr_b16 v[238:239], v12 offset:11264
    buffer_load_dwordx4 v[200:203], v16, s[40:43], s68 offen offset:2048 sc1
    v_add_f32 v40, v40, v56
    v_add_f32 v41, v41, v57
    v_add_f32 v42, v42, v58
    v_add_f32 v43, v43, v59
    v_mfma_f32_32x32x16_bf16 v[152:167], v[216:219], v[108:111], v[152:167]
    buffer_load_dwordx4 v[204:207], v16, s[40:43], s68 offen offset:3072 sc1
    ds_read_b128 v[72:75], v22 offset:6144
    ds_read_b128 v[76:79], v22 offset:7168
    v_add_f32 v44, v44, v60
    v_add_f32 v45, v45, v61
    v_add_f32 v46, v46, v62
    v_add_f32 v47, v47, v63
    s_waitcnt vmcnt(11)
    s_waitcnt lgkmcnt(6)
    v_mfma_f32_32x32x16_bf16 v[168:183], v[228:231], v[112:115], v[168:183]
    ds_read_b64_tr_b16 v[240:241], v11 offset:12288
    ds_read_b64_tr_b16 v[242:243], v11 offset:13312
    ds_read_b64_tr_b16 v[244:245], v12 offset:12288
    ds_read_b64_tr_b16 v[246:247], v12 offset:13312
    v_add_f32 v32, v32, v64
    v_add_f32 v33, v33, v65
    v_add_f32 v34, v34, v66
    v_add_f32 v35, v35, v67
    v_mfma_f32_32x32x16_bf16 v[152:167], v[224:227], v[112:115], v[152:167]
    ds_read_b128 v[80:83], v23 offset:8192
    ds_read_b128 v[84:87], v23 offset:9216
    v_add_f32 v36, v36, v68
    v_add_f32 v37, v37, v69
    v_add_f32 v38, v38, v70
    v_add_f32 v39, v39, v71
    s_waitcnt vmcnt(10)
    s_waitcnt lgkmcnt(6)
    v_mfma_f32_32x32x16_bf16 v[168:183], v[236:239], v[116:119], v[168:183]
    ds_read_b64_tr_b16 v[248:249], v11 offset:14336
    ds_read_b64_tr_b16 v[250:251], v11 offset:15360
    ds_read_b64_tr_b16 v[252:253], v12 offset:14336
    ds_read_b64_tr_b16 v[254:255], v12 offset:15360
    v_add_f32 v40, v40, v72
    v_add_f32 v41, v41, v73
    v_add_f32 v42, v42, v74
    v_add_f32 v43, v43, v75
    v_mfma_f32_32x32x16_bf16 v[152:167], v[232:235], v[116:119], v[152:167]
    ds_read_b128 v[88:91], v23 offset:10240
    ds_read_b128 v[92:95], v23 offset:11264
    v_add_f32 v44, v44, v76
    v_add_f32 v45, v45, v77
    v_add_f32 v46, v46, v78
    v_add_f32 v47, v47, v79
    s_waitcnt vmcnt(9)
    s_waitcnt lgkmcnt(6)
    v_mfma_f32_32x32x16_bf16 v[168:183], v[244:247], v[120:123], v[168:183]
    ds_read_b64_tr_b16 v[184:185], v14 offset:0
    ds_read_b64_tr_b16 v[186:187], v14 offset:1024
    ds_read_b64_tr_b16 v[188:189], v18 offset:0
    ds_read_b64_tr_b16 v[190:191], v18 offset:1024
    v_add_f32 v32, v32, v80
    v_add_f32 v33, v33, v81
    v_add_f32 v34, v34, v82
    v_add_f32 v35, v35, v83
    v_mfma_f32_32x32x16_bf16 v[152:167], v[240:243], v[120:123], v[152:167]
    v_add_f32 v36, v36, v84
    v_add_f32 v37, v37, v85
    v_add_f32 v38, v38, v86
    v_add_f32 v39, v39, v87
    s_waitcnt vmcnt(8)
    s_waitcnt lgkmcnt(4)
    v_mfma_f32_32x32x16_bf16 v[168:183], v[252:255], v[124:127], v[168:183]
    ds_read_b64_tr_b16 v[192:193], v14 offset:2048
    ds_read_b64_tr_b16 v[194:195], v14 offset:3072
    ds_read_b64_tr_b16 v[196:197], v18 offset:2048
    ds_read_b64_tr_b16 v[198:199], v18 offset:3072
    v_add_f32 v40, v40, v88
    v_add_f32 v41, v41, v89
    v_add_f32 v42, v42, v90
    v_add_f32 v43, v43, v91
    v_mfma_f32_32x32x16_bf16 v[152:167], v[248:251], v[124:127], v[152:167]
    v_add_f32 v44, v44, v92
    v_add_f32 v45, v45, v93
    v_add_f32 v46, v46, v94
    v_add_f32 v47, v47, v95
    ds_read_b64_tr_b16 v[208:209], v14 offset:4096
    ds_read_b64_tr_b16 v[210:211], v14 offset:5120
    ds_read_b64_tr_b16 v[212:213], v18 offset:4096
    ds_read_b64_tr_b16 v[214:215], v18 offset:5120
    s_waitcnt lgkmcnt(8)
    ds_read_b64_tr_b16 v[216:217], v14 offset:6144
    ds_read_b64_tr_b16 v[218:219], v14 offset:7168
    ds_read_b64_tr_b16 v[220:221], v18 offset:6144
    ds_read_b64_tr_b16 v[222:223], v18 offset:7168
    s_waitcnt lgkmcnt(8)
    ds_read_b64_tr_b16 v[224:225], v14 offset:8192
    ds_read_b64_tr_b16 v[226:227], v14 offset:9216
    ds_read_b64_tr_b16 v[228:229], v18 offset:8192
    ds_read_b64_tr_b16 v[230:231], v18 offset:9216
    s_waitcnt lgkmcnt(8)
    ds_read_b64_tr_b16 v[232:233], v14 offset:10240
    ds_read_b64_tr_b16 v[234:235], v14 offset:11264
    ds_read_b64_tr_b16 v[236:237], v18 offset:10240
    ds_read_b64_tr_b16 v[238:239], v18 offset:11264
    s_waitcnt lgkmcnt(8)
    ds_read_b64_tr_b16 v[240:241], v14 offset:12288
    ds_read_b64_tr_b16 v[242:243], v14 offset:13312
    ds_read_b64_tr_b16 v[244:245], v18 offset:12288
    ds_read_b64_tr_b16 v[246:247], v18 offset:13312
    s_waitcnt lgkmcnt(8)
    ds_read_b64_tr_b16 v[248:249], v14 offset:14336
    ds_read_b64_tr_b16 v[250:251], v14 offset:15360
    ds_read_b64_tr_b16 v[252:253], v18 offset:14336
    ds_read_b64_tr_b16 v[254:255], v18 offset:15360
    s_waitcnt lgkmcnt(8)
    s_cmp_lg_u32 s67, 0
    s_cbranch_scc1 L_ojoin_65
    s_waitcnt lgkmcnt(0)
    s_cmp_ge_u32 s69, 8
    s_cbranch_scc1 L_oseen_68
    s_mov_b32 s70, 200000
L_spoll_69:
    s_mov_b32 s69, 0
    s_atomic_add s69, s[40:41], s11 glc
    s_waitcnt lgkmcnt(0)
    s_cmp_ge_u32 s69, 8
    s_cbranch_scc1 L_sdone_70
    s_sub_u32 s70, s70, 1
    s_cmp_lg_u32 s70, 0
    s_cbranch_scc1 L_spoll_69
L_sdone_70:
L_oseen_68:
    s_waitcnt vmcnt(0)
    buffer_load_dwordx4 v[128:131], v16, s[40:43], s7 offen offset:0 sc1
    buffer_load_dwordx4 v[132:135], v16, s[40:43], s7 offen offset:1024 sc1
    buffer_load_dwordx4 v[136:139], v16, s[40:43], s7 offen offset:2048 sc1
    buffer_load_dwordx4 v[140:143], v16, s[40:43], s7 offen offset:3072 sc1
    s_add_u32 s7, s7, 4096
    buffer_load_dwordx4 v[144:147], v16, s[40:43], s7 offen offset:0 sc1
    buffer_load_dwordx4 v[148:151], v16, s[40:43], s7 offen offset:1024 sc1
    buffer_load_dwordx4 v[200:203], v16, s[40:43], s7 offen offset:2048 sc1
    buffer_load_dwordx4 v[204:207], v16, s[40:43], s7 offen offset:3072 sc1
L_ojoin_65:
    s_waitcnt vmcnt(7)
    v_mfma_f32_32x32x16_bf16 v[80:95], v[188:191], v[128:131], 0
    v_permlane16_swap_b32 v32, v36
    v_mul_f32 v32, v32, v4
    v_mul_f32 v36, v36, v4
    s_waitcnt vmcnt(6)
    v_mfma_f32_32x32x16_bf16 v[80:95], v[196:199], v[132:135], v[80:95]
    v_permlane16_swap_b32 v33, v37
    v_mul_f32 v33, v33, v4
    v_mul_f32 v37, v37, v4
    s_waitcnt vmcnt(5)
    v_mfma_f32_32x32x16_bf16 v[80:95], v[212:215], v[136:139], v[80:95]
    v_permlane16_swap_b32 v34, v38
    v_mul_f32 v34, v34, v4
    v_mul_f32 v38, v38, v4
    s_waitcnt vmcnt(4)
    v_mfma_f32_32x32x16_bf16 v[80:95], v[220:223], v[140:143], v[80:95]
    v_permlane16_swap_b32 v35, v39
    v_mul_f32 v35, v35, v4
    v_mul_f32 v39, v39, v4
    s_waitcnt vmcnt(3)
    v_mfma_f32_32x32x16_bf16 v[80:95], v[228:231], v[144:147], v[80:95]
    v_permlane16_swap_b32 v40, v44
    v_mul_f32 v40, v40, v4
    v_mul_f32 v44, v44, v4
    s_waitcnt vmcnt(2)
    v_mfma_f32_32x32x16_bf16 v[80:95], v[236:239], v[148:151], v[80:95]
    v_permlane16_swap_b32 v41, v45
    v_mul_f32 v41, v41, v4
    v_mul_f32 v45, v45, v4
    s_waitcnt vmcnt(1)
    s_waitcnt lgkmcnt(4)
    v_mfma_f32_32x32x16_bf16 v[80:95], v[244:247], v[200:203], v[80:95]
    v_permlane16_swap_b32 v42, v46
    v_mul_f32 v42, v42, v4
    v_mul_f32 v46, v46, v4
    s_waitcnt vmcnt(0)
    s_waitcnt lgkmcnt(0)
    v_mfma_f32_32x32x16_bf16 v[80:95], v[252:255], v[204:207], v[80:95]
    v_permlane16_swap_b32 v43, v47
    v_mul_f32 v43, v43, v4
    v_mul_f32 v47, v47, v4
    v_mfma_f32_32x32x16_bf16 v[64:79], v[184:187], v[128:131], 0
    s_nop 5
    v_mfma_f32_32x32x16_bf16 v[64:79], v[192:195], v[132:135], v[64:79]
    s_nop 3
    v_add_f32 v168, v168, v80
    v_add_f32 v169, v169, v81
    v_add_f32 v170, v170, v82
    v_add_f32 v171, v171, v83
    ds_write_b128 v31, v[168:171] offset:0
    v_mfma_f32_32x32x16_bf16 v[64:79], v[208:211], v[136:139], v[64:79]
    v_add_f32 v172, v172, v84
    v_add_f32 v173, v173, v85
    v_add_f32 v174, v174, v86
    v_add_f32 v175, v175, v87
    ds_write_b128 v31, v[172:175] offset:1024
    v_mfma_f32_32x32x16_bf16 v[64:79], v[216:219], v[140:143], v[64:79]
    v_add_f32 v176, v176, v88
    v_add_f32 v177, v177, v89
    v_add_f32 v178, v178, v90
    v_add_f32 v179, v179, v91
    ds_write_b128 v31, v[176:179] offset:2048
    v_mfma_f32_32x32x16_bf16 v[64:79], v[224:227], v[144:147], v[64:79]
    v_add_f32 v180, v180, v92
    v_add_f32 v181, v181, v93
    v_add_f32 v182, v182, v94
    v_add_f32 v183, v183, v95
    ds_write_b128 v31, v[180:183] offset:3072
    v_mfma_f32_32x32x16_bf16 v[64:79], v[232:235], v[148:151], v[64:79]
    s_waitcnt lgkmcnt(0)
    s_barrier
    ds_read_b128 v[48:51], v20 offset:0
    ds_read_b128 v[52:55], v20 offset:1024
    ds_read_b128 v[56:59], v20 offset:2048
    ds_read_b128 v[60:63], v20 offset:3072
    v_mfma_f32_32x32x16_bf16 v[64:79], v[240:243], v[200:203], v[64:79]
    v_mfma_f32_32x32x16_bf16 v[64:79], v[248:251], v[204:207], v[64:79]
    s_waitcnt lgkmcnt(3)
    v_fmac_f32 v32, v48, v2
    v_fmac_f32 v33, v49, v2
    v_fmac_f32 v34, v50, v2
    v_fmac_f32 v35, v51, v2
    s_waitcnt lgkmcnt(2)
    v_fmac_f32 v36, v52, v2
    v_fmac_f32 v37, v53, v2
    v_fmac_f32 v38, v54, v2
    v_fmac_f32 v39, v55, v2
    s_waitcnt lgkmcnt(1)
    v_fmac_f32 v40, v56, v2
    v_fmac_f32 v41, v57, v2
    v_fmac_f32 v42, v58, v2
    v_fmac_f32 v43, v59, v2
    s_waitcnt lgkmcnt(0)
    v_fmac_f32 v44, v60, v2
    v_fmac_f32 v45, v61, v2
    v_fmac_f32 v46, v62, v2
    v_fmac_f32 v47, v63, v2
    v_pk_add_f32 v[152:153], v[152:153], v[64:65]
    v_pk_add_f32 v[154:155], v[154:155], v[66:67]
    v_pk_add_f32 v[156:157], v[156:157], v[68:69]
    v_pk_add_f32 v[158:159], v[158:159], v[70:71]
    v_pk_fma_f32 v[32:33], v[152:153], v[2:3], v[32:33] op_sel_hi:[1,0,1]
    v_pk_fma_f32 v[34:35], v[154:155], v[2:3], v[34:35] op_sel_hi:[1,0,1]
    v_pk_fma_f32 v[36:37], v[156:157], v[2:3], v[36:37] op_sel_hi:[1,0,1]
    v_pk_fma_f32 v[38:39], v[158:159], v[2:3], v[38:39] op_sel_hi:[1,0,1]
    v_cvt_pk_bf16_f32 v48, v32, v33
    v_cvt_pk_bf16_f32 v49, v34, v35
    v_cvt_pk_bf16_f32 v50, v36, v37
    v_cvt_pk_bf16_f32 v51, v38, v39
    buffer_store_dwordx4 v[48:51], v30, s[32:35], s6 offen offset:0
    v_pk_add_f32 v[160:161], v[160:161], v[72:73]
    v_pk_add_f32 v[162:163], v[162:163], v[74:75]
    v_pk_add_f32 v[164:165], v[164:165], v[76:77]
    v_pk_add_f32 v[166:167], v[166:167], v[78:79]
    v_pk_fma_f32 v[40:41], v[160:161], v[2:3], v[40:41] op_sel_hi:[1,0,1]
    v_pk_fma_f32 v[42:43], v[162:163], v[2:3], v[42:43] op_sel_hi:[1,0,1]
    v_pk_fma_f32 v[44:45], v[164:165], v[2:3], v[44:45] op_sel_hi:[1,0,1]
    v_pk_fma_f32 v[46:47], v[166:167], v[2:3], v[46:47] op_sel_hi:[1,0,1]
    v_cvt_pk_bf16_f32 v52, v40, v41
    v_cvt_pk_bf16_f32 v53, v42, v43
    v_cvt_pk_bf16_f32 v54, v44, v45
    v_cvt_pk_bf16_f32 v55, v46, v47
    buffer_store_dwordx4 v[52:55], v30, s[32:35], s6 offen offset:16
L_end:
    s_endpgm
L_tk0:
    ds_read_b32 v7, v5 offset:52
    s_waitcnt lgkmcnt(0)
    v_cmp_gt_u32 vcc, 4, v7
    s_cbranch_vccz L_ldone_72
    s_mov_b32 s70, 1000000
L_lspin_71:
    s_sleep 1
    ds_read_b32 v7, v5 offset:52
    s_waitcnt lgkmcnt(0)
    v_cmp_gt_u32 vcc, 4, v7
    s_cbranch_vccz L_ldone_72
    s_sub_u32 s70, s70, 1
    s_cmp_lg_u32 s70, 0
    s_cbranch_scc1 L_lspin_71
L_ldone_72:
    s_lshl_b32 s69, s45, 7
    s_add_u32 s69, s69, 12664832
    s_mov_b32 s53, 1
    s_atomic_add s53, s[40:41], s69 glc
    s_branch L_tk_back0
L_tk1:
    s_waitcnt lgkmcnt(0)
    s_add_u32 s53, s53, 1
    v_mov_b32 v7, s53
    ds_write_b32 v5, v7 offset:56
    s_waitcnt lgkmcnt(0)
    s_branch L_tk_back1
L_skipper:
    s_waitcnt vmcnt(0)
    s_lshl_b32 s62, s45, 1
    s_lshr_b32 s63, s47, 1
    s_add_u32 s62, s62, s63
    s_lshl_b32 s62, s62, 2
    s_lshr_b32 s63, s44, 2
    s_add_u32 s62, s62, s63
    s_lshl_b32 s62, s62, 7
    s_add_u32 s62, s62, 12599296
    s_atomic_add s71, s[40:41], s62
    v_mov_b32 v7, 8
    s_mov_b64 exec, 1
    ds_add_u32 v5, v7 offset:0
    s_mov_b64 exec, -1
    s_setprio 3
    s_cmp_lg_u32 s53, 11
    s_cbranch_scc1 L_nologit
    v_mbcnt_lo_u32_b32 v105, -1, 0
    v_mbcnt_hi_u32_b32 v105, -1, v105
    v_lshrrev_b32 v104, 5, v105
    v_lshlrev_b32 v104, 4, v104
    v_bfe_u32 v106, v105, 4, 1
    v_lshl_add_u32 v104, v106, 5, v104
    v_lshlrev_b32 v105, 2, v105
    s_add_u32 s58, s51, 0
    s_and_b32 s58, s58, 3
    s_add_u32 s58, s58, s48
    s_lshl_b32 s58, s58, 7
    buffer_load_dwordx4 v[32:35], v104, s[28:31], s58 offen offset:0
    buffer_load_dwordx4 v[36:39], v104, s[28:31], s58 offen offset:64
    s_add_u32 s58, s51, 1
    s_and_b32 s58, s58, 3
    s_add_u32 s58, s58, s48
    s_lshl_b32 s58, s58, 7
    buffer_load_dwordx4 v[40:43], v104, s[28:31], s58 offen offset:0
    buffer_load_dwordx4 v[44:47], v104, s[28:31], s58 offen offset:64
    s_add_u32 s58, s51, 2
    s_and_b32 s58, s58, 3
    s_add_u32 s58, s58, s48
    s_lshl_b32 s58, s58, 7
    buffer_load_dwordx4 v[48:51], v104, s[28:31], s58 offen offset:0
    buffer_load_dwordx4 v[52:55], v104, s[28:31], s58 offen offset:64
    s_add_u32 s58, s51, 3
    s_and_b32 s58, s58, 3
    s_add_u32 s58, s58, s48
    s_lshl_b32 s58, s58, 7
    buffer_load_dwordx4 v[56:59], v104, s[28:31], s58 offen offset:0
    buffer_load_dwordx4 v[60:63], v104, s[28:31], s58 offen offset:64
    s_add_u32 s58, s51, 0
    s_and_b32 s58, s58, 3
    s_add_u32 s58, s58, s48
    s_xor_b32 s58, s58, 4
    s_lshl_b32 s58, s58, 7
    buffer_load_dwordx4 v[64:67], v104, s[28:31], s58 offen offset:0
    buffer_load_dwordx4 v[68:71], v104, s[28:31], s58 offen offset:64
    s_add_u32 s58, s51, 1
    s_and_b32 s58, s58, 3
    s_add_u32 s58, s58, s48
    s_xor_b32 s58, s58, 4
    s_lshl_b32 s58, s58, 7
    buffer_load_dwordx4 v[72:75], v104, s[28:31], s58 offen offset:0
    buffer_load_dwordx4 v[76:79], v104, s[28:31], s58 offen offset:64
    s_add_u32 s58, s51, 2
    s_and_b32 s58, s58, 3
    s_add_u32 s58, s58, s48
    s_xor_b32 s58, s58, 4
    s_lshl_b32 s58, s58, 7
    buffer_load_dwordx4 v[80:83], v104, s[28:31], s58 offen offset:0
    buffer_load_dwordx4 v[84:87], v104, s[28:31], s58 offen offset:64
    s_add_u32 s58, s51, 3
    s_and_b32 s58, s58, 3
    s_add_u32 s58, s58, s48
    s_xor_b32 s58, s58, 4
    s_lshl_b32 s58, s58, 7
    buffer_load_dwordx4 v[88:91], v104, s[28:31], s58 offen offset:0
    buffer_load_dwordx4 v[92:95], v104, s[28:31], s58 offen offset:64
    s_lshl_b32 s58, s45, 2
    s_add_u32 s58, s58, s47
    s_lshl_b32 s58, s58, 7
    s_add_u32 s58, s58, 12320768
    s_waitcnt vmcnt(0)
    v_mfma_f32_16x16x32_bf16 v[96:99], v[32:35], v[128:131], 0
    v_mfma_f32_16x16x32_bf16 v[100:103], v[32:35], v[132:135], 0
    v_mfma_f32_16x16x32_bf16 v[96:99], v[36:39], v[136:139], v[96:99]
    v_mfma_f32_16x16x32_bf16 v[100:103], v[36:39], v[140:143], v[100:103]
    v_mfma_f32_16x16x32_bf16 v[96:99], v[40:43], v[144:147], v[96:99]
    v_mfma_f32_16x16x32_bf16 v[100:103], v[40:43], v[148:151], v[100:103]
    v_mfma_f32_16x16x32_bf16 v[96:99], v[44:47], v[152:155], v[96:99]
    v_mfma_f32_16x16x32_bf16 v[100:103], v[44:47], v[156:159], v[100:103]
    v_mfma_f32_16x16x32_bf16 v[96:99], v[48:51], v[160:163], v[96:99]
    v_mfma_f32_16x16x32_bf16 v[100:103], v[48:51], v[164:167], v[100:103]
    v_mfma_f32_16x16x32_bf16 v[96:99], v[52:55], v[168:171], v[96:99]
    v_mfma_f32_16x16x32_bf16 v[100:103], v[52:55], v[172:175], v[100:103]
    v_mfma_f32_16x16x32_bf16 v[96:99], v[56:59], v[176:179], v[96:99]
    v_mfma_f32_16x16x32_bf16 v[100:103], v[56:59], v[180:183], v[100:103]
    v_mfma_f32_16x16x32_bf16 v[96:99], v[60:63], v[184:187], v[96:99]
    v_mfma_f32_16x16x32_bf16 v[100:103], v[60:63], v[188:191], v[100:103]
    v_mfma_f32_16x16x32_bf16 v[96:99], v[64:67], v[192:195], v[96:99]
    v_mfma_f32_16x16x32_bf16 v[100:103], v[64:67], v[196:199], v[100:103]
    v_mfma_f32_16x16x32_bf16 v[96:99], v[68:71], v[200:203], v[96:99]
    v_mfma_f32_16x16x32_bf16 v[100:103], v[68:71], v[204:207], v[100:103]
    v_mfma_f32_16x16x32_bf16 v[96:99], v[72:75], v[208:211], v[96:99]
    v_mfma_f32_16x16x32_bf16 v[100:103], v[72:75], v[212:215], v[100:103]
    v_mfma_f32_16x16x32_bf16 v[96:99], v[76:79], v[216:219], v[96:99]
    v_mfma_f32_16x16x32_bf16 v[100:103], v[76:79], v[220:223], v[100:103]
    v_mfma_f32_16x16x32_bf16 v[96:99], v[80:83], v[224:227], v[96:99]
    v_mfma_f32_16x16x32_bf16 v[100:103], v[80:83], v[228:231], v[100:103]
    v_mfma_f32_16x16x32_bf16 v[96:99], v[84:87], v[232:235], v[96:99]
    v_mfma_f32_16x16x32_bf16 v[100:103], v[84:87], v[236:239], v[100:103]
    v_mfma_f32_16x16x32_bf16 v[96:99], v[88:91], v[240:243], v[96:99]
    v_mfma_f32_16x16x32_bf16 v[100:103], v[88:91], v[244:247], v[100:103]
    v_mfma_f32_16x16x32_bf16 v[96:99], v[92:95], v[248:251], v[96:99]
    v_mfma_f32_16x16x32_bf16 v[100:103], v[92:95], v[252:255], v[100:103]
    s_nop 6
    s_mov_b64 exec, 0xffff
    buffer_store_dword v96, v105, s[40:43], s58 offen sc1
    buffer_store_dword v100, v105, s[40:43], s58 offen offset:64 sc1
    s_mov_b64 exec, -1
    s_waitcnt vmcnt(0)
    s_lshl_b32 s62, s45, 1
    s_lshr_b32 s63, s47, 1
    s_add_u32 s62, s62, s63
    s_lshl_b32 s62, s62, 2
    s_mov_b32 s63, 0
    s_add_u32 s62, s62, s63
    s_lshl_b32 s62, s62, 7
    s_add_u32 s62, s62, 12648448
    s_atomic_add s71, s[40:41], s62
    s_add_u32 s62, s62, 128
    s_atomic_add s71, s[40:41], s62
    s_add_u32 s62, s62, 128
    s_atomic_add s71, s[40:41], s62
    s_add_u32 s62, s62, 128
    s_atomic_add s71, s[40:41], s62
L_nologit:
    s_mul_i32 s54, s47, 12352
    s_mul_i32 s4, s47, 6144
    s_add_u32 s4, s4, 49408
    s_and_b32 s57, s49, 3
    s_lshl_b32 s57, s57, 1
    s_add_u32 s57, s57, s50
    s_lshl_b32 s57, s57, 1
    s_and_b32 s57, s57, 15
    s_mov_b32 s59, s57
    s_lshl_b32 s58, s47, 18
    s_lshl_b32 s55, s50, 7
    s_add_u32 s58, s58, s55
    s_mul_i32 s60, s49, 172
    s_lshl_b32 s55, s47, 4
    s_add_u32 s60, s60, s55
    s_lshl_b32 s60, s60, 10
    s_add_u32 s60, s60, 6291456
    v_mbcnt_lo_u32_b32 v8, -1, 0
    v_mbcnt_hi_u32_b32 v8, -1, v8
    v_lshlrev_b32 v16, 4, v8
    s_and_b32 s55, s47, 1
    s_mul_i32 s55, s55, 88064
    v_bfe_u32 v22, v8, 4, 1
    v_mul_u32_u24 v20, 768, v22
    v_add_u32 v20, v20, v16
    v_add_u32 v10, s55, v20
    s_sub_u32 s55, 88064, s55
    v_add_u32 v19, s55, v20
    v_add_u32 v15, s54, v16
    v_lshrrev_b32 v20, 5, v8
    v_bfe_u32 v21, v8, 2, 2
    v_lshl_add_u32 v20, v20, 2, v21
    v_and_b32 v21, 1, v8
    v_lshlrev_b32 v21, 2, v21
    v_lshl_add_u32 v21, v22, 1, v21
    v_bfe_u32 v23, v8, 1, 1
    v_add_u32 v21, v21, v23
    v_lshlrev_b32 v21, 3, v21
    v_lshl_add_u32 v21, v20, 7, v21
    v_bfe_u32 v23, v8, 3, 1
    v_lshl_add_u32 v21, v23, 6, v21
    s_lshr_b32 s55, s47, 1
    s_lshl_b32 s55, s55, 6
    v_xor_b32 v9, s55, v21
    v_and_b32 v20, 0x3d0, v9
    v_lshl_add_u32 v20, v22, 11, v20
    v_and_b32 v21, 1, v8
    v_lshl_add_u32 v20, v21, 3, v20
    v_and_b32 v21, 2, v8
    v_lshl_add_u32 v20, v21, 4, v20
    v_xor_b32 v21, 64, v20
    v_add_u32 v11, s54, v20
    v_add_u32 v12, s54, v21
    v_add_u32 v14, s4, v20
    v_add_u32 v18, s4, v21
    s_lshl_b32 s55, s47, 2
    v_add_u32 v13, s55, v5
    v_and_b32 v17, 31, v8
    v_lshlrev_b32 v30, 10, v17
    v_lshlrev_b32 v17, 2, v17
    v_lshrrev_b32 v20, 5, v8
    v_lshl_add_u32 v30, v20, 5, v30
    v_add_u32 v31, s4, v16
    s_xor_b32 s55, s47, 2
    s_mul_i32 s55, s55, 6144
    s_add_u32 s55, s55, 49408
    v_add_u32 v20, s55, v16
    s_xor_b32 s55, s47, 2
    s_mul_i32 s55, s55, 12352
    v_add_u32 v21, s55, v16
    s_xor_b32 s55, s47, 1
    s_mul_i32 s55, s55, 12352
    v_add_u32 v22, s55, v16
    s_xor_b32 s55, s47, 3
    s_mul_i32 s55, s55, 12352
    v_add_u32 v23, s55, v16
    s_add_u32 m0, s54, 0
    s_lshl_b32 s56, s57, 14
    s_add_u32 s56, s56, s58
    buffer_load_dwordx4 v1, s[24:27], s56 offen lds
    buffer_load_dwordx4 v2, s[24:27], s56 offen offset:1024 lds
    s_add_u32 m0, s54, 2064
    s_add_u32 s57, s57, 1
    s_and_b32 s57, s57, 15
    s_lshl_b32 s56, s57, 14
    s_add_u32 s56, s56, s58
    buffer_load_dwordx4 v1, s[24:27], s56 offen lds
    buffer_load_dwordx4 v2, s[24:27], s56 offen offset:1024 lds
    s_add_u32 m0, s54, 4112
    s_add_u32 s57, s57, 1
    s_and_b32 s57, s57, 15
    s_lshl_b32 s56, s57, 14
    s_add_u32 s56, s56, s58
    buffer_load_dwordx4 v1, s[24:27], s56 offen lds
    buffer_load_dwordx4 v2, s[24:27], s56 offen offset:1024 lds
    s_add_u32 m0, s54, 6176
    s_add_u32 s57, s57, 1
    s_and_b32 s57, s57, 15
    s_lshl_b32 s56, s57, 14
    s_add_u32 s56, s56, s58
    buffer_load_dwordx4 v1, s[24:27], s56 offen lds
    buffer_load_dwordx4 v2, s[24:27], s56 offen offset:1024 lds
    s_waitcnt vmcnt(6)
    s_add_u32 m0, s54, 8224
    s_add_u32 s57, s57, 1
    s_and_b32 s57, s57, 15
    s_lshl_b32 s56, s57, 14
    s_add_u32 s56, s56, s58
    buffer_load_dwordx4 v1, s[24:27], s56 offen lds
    buffer_load_dwordx4 v2, s[24:27], s56 offen offset:1024 lds
    s_waitcnt vmcnt(6)
    s_add_u32 m0, s54, 10288
    s_add_u32 s57, s57, 1
    s_and_b32 s57, s57, 15
    s_lshl_b32 s56, s57, 14
    s_add_u32 s56, s56, s58
    buffer_load_dwordx4 v1, s[24:27], s56 offen lds
    buffer_load_dwordx4 v2, s[24:27], s56 offen offset:1024 lds
    s_waitcnt vmcnt(6)
    s_add_u32 m0, s4, 0
    s_add_u32 s57, s57, 1
    s_and_b32 s57, s57, 15
    s_lshl_b32 s56, s57, 14
    s_add_u32 s56, s56, s58
    buffer_load_dwordx4 v1, s[24:27], s56 offen lds
    buffer_load_dwordx4 v2, s[24:27], s56 offen offset:1024 lds
    s_waitcnt vmcnt(6)
    s_add_u32 m0, s4, 2064
    s_add_u32 s57, s57, 1
    s_and_b32 s57, s57, 15
    s_lshl_b32 s56, s57, 14
    s_add_u32 s56, s56, s58
    buffer_load_dwordx4 v1, s[24:27], s56 offen lds
    buffer_load_dwordx4 v2, s[24:27], s56 offen offset:1024 lds
    s_waitcnt vmcnt(6)
    s_lshl_b32 s64, s49, 2
    s_add_u32 s64, s64, s47
    s_lshl_b32 s64, s64, 7
    s_add_u32 s64, s64, 12599296
    s_mov_b32 s69, 0
    s_atomic_add s69, s[40:41], s64 glc
    s_branch L_ffn2
L_kv_wait:
    s_mov_b32 s70, 200000
L_spoll_73:
    s_mov_b32 s69, 0
    s_atomic_add s69, s[40:41], s68 glc
    s_waitcnt lgkmcnt(0)
    s_cmp_ge_u32 s69, 8
    s_cbranch_scc1 L_kv_ok
    s_sub_u32 s70, s70, 1
    s_cmp_lg_u32 s70, 0
    s_cbranch_scc1 L_spoll_73
    s_branch L_kv_ok
L_rdv:
    s_mov_b64 exec, 1
    ds_add_u32 v5, v7 offset:52
    s_mov_b64 exec, -1
    ds_read_b32 v4, v5 offset:0
    s_waitcnt lgkmcnt(0)
    v_cmp_gt_u32 vcc, 128, v4
    s_cbranch_vccz L_ldone_75
    s_mov_b32 s70, 1000000
L_lspin_74:
    s_sleep 1
    ds_read_b32 v4, v5 offset:0
    s_waitcnt lgkmcnt(0)
    v_cmp_gt_u32 vcc, 128, v4
    s_cbranch_vccz L_ldone_75
    s_sub_u32 s70, s70, 1
    s_cmp_lg_u32 s70, 0
    s_cbranch_scc1 L_lspin_74
L_ldone_75:
    s_branch L_rdv_ok
L_fallback:
    s_waitcnt vmcnt(0)
    v_mov_b32 v4, 0xff800000
    s_lshl_b32 s56, s44, 1
    s_add_u32 s56, s56, s62
    s_lshl_b32 s56, s56, 17
    s_mov_b32 s57, 64
L_fb_max0:
    buffer_load_dwordx4 v[128:131], v13, s[40:43], s56 offen sc1
    s_waitcnt vmcnt(0)
    v_mfma_f32_32x32x16_bf16 v[80:95], v[128:131], v[120:123], 0
    s_nop 11
    v_max3_f32 v4, v80, v81, v4
    v_max3_f32 v4, v82, v83, v4
    v_max3_f32 v4, v84, v85, v4
    v_max3_f32 v4, v86, v87, v4
    v_max3_f32 v4, v88, v89, v4
    v_max3_f32 v4, v90, v91, v4
    v_max3_f32 v4, v92, v93, v4
    v_max3_f32 v4, v94, v95, v4
    s_add_u32 s56, s56, 2048
    s_sub_u32 s57, s57, 1
    s_cmp_lg_u32 s57, 0
    s_cbranch_scc1 L_fb_max0
    v_mov_b32 v96, v4
    s_nop 1
    v_permlane32_swap_b32 v4, v96
    s_nop 1
    v_max_f32 v4, v4, v96
    s_sub_u32 s56, s56, 131072
    s_mov_b32 s57, 64
    v_sub_f32 v96, 0, v4
    v_mov_b32 v48, 0
    v_sub_f32 v97, 0, v4
    v_mov_b32 v49, 0
    v_sub_f32 v98, 0, v4
    v_mov_b32 v50, 0
    v_sub_f32 v99, 0, v4
    v_mov_b32 v51, 0
    v_sub_f32 v100, 0, v4
    v_mov_b32 v52, 0
    v_sub_f32 v101, 0, v4
    v_mov_b32 v53, 0
    v_sub_f32 v102, 0, v4
    v_mov_b32 v54, 0
    v_sub_f32 v103, 0, v4
    v_mov_b32 v55, 0
    v_sub_f32 v104, 0, v4
    v_mov_b32 v56, 0
    v_sub_f32 v105, 0, v4
    v_mov_b32 v57, 0
    v_sub_f32 v106, 0, v4
    v_mov_b32 v58, 0
    v_sub_f32 v107, 0, v4
    v_mov_b32 v59, 0
    v_sub_f32 v108, 0, v4
    v_mov_b32 v60, 0
    v_sub_f32 v109, 0, v4
    v_mov_b32 v61, 0
    v_sub_f32 v110, 0, v4
    v_mov_b32 v62, 0
    v_sub_f32 v111, 0, v4
    v_mov_b32 v63, 0
L_fb_sum0:
    buffer_load_dwordx4 v[128:131], v13, s[40:43], s56 offen sc1
    s_mov_b64 exec, s[52:53]
    buffer_load_dwordx4 v[132:135], v14, s[40:43], s56 offen offset:1024 sc1
    buffer_load_dwordx4 v[136:139], v14, s[40:43], s56 offen offset:1536 sc1
    s_mov_b64 exec, -1
    s_waitcnt vmcnt(0)
    v_mfma_f32_32x32x16_bf16 v[80:95], v[128:131], v[120:123], v[96:111]
    s_nop 11
    v_exp_f32 v80, v80
    v_exp_f32 v81, v81
    v_exp_f32 v82, v82
    v_exp_f32 v83, v83
    v_exp_f32 v84, v84
    v_exp_f32 v85, v85
    v_exp_f32 v86, v86
    v_exp_f32 v87, v87
    v_exp_f32 v88, v88
    v_exp_f32 v89, v89
    v_exp_f32 v90, v90
    v_exp_f32 v91, v91
    v_exp_f32 v92, v92
    v_exp_f32 v93, v93
    v_exp_f32 v94, v94
    v_exp_f32 v95, v95
    s_nop 1
    v_smfmac_f32_32x32x32_bf16 v[48:63], v[132:135], v[80:87], v12
    v_smfmac_f32_32x32x32_bf16 v[48:63], v[136:139], v[88:95], v12
    s_nop 7
    s_add_u32 s56, s56, 2048
    s_sub_u32 s57, s57, 1
    s_cmp_lg_u32 s57, 0
    s_cbranch_scc1 L_fb_sum0
    s_nop 3
    v_rcp_f32 v57, v56
    s_add_u32 s58, s54, 0
    v_mul_f32 v48, v48, v57
    v_mul_f32 v49, v49, v57
    v_mul_f32 v50, v50, v57
    v_mul_f32 v51, v51, v57
    v_mul_f32 v52, v52, v57
    v_mul_f32 v53, v53, v57
    v_mul_f32 v54, v54, v57
    v_mul_f32 v55, v55, v57
    v_cvt_pk_bf16_f32 v224, v48, v49
    v_cvt_pk_bf16_f32 v225, v50, v51
    v_cvt_pk_bf16_f32 v226, v52, v53
    v_cvt_pk_bf16_f32 v227, v54, v55
    buffer_store_dwordx4 v[224:227], v13, s[40:43], s58 offen sc1
    v_mov_b32 v4, 0xff800000
    s_lshl_b32 s56, s44, 1
    s_add_u32 s56, s56, s62
    s_lshl_b32 s56, s56, 17
    s_mov_b32 s57, 64
L_fb_max1:
    buffer_load_dwordx4 v[128:131], v13, s[40:43], s56 offen sc1
    s_waitcnt vmcnt(0)
    v_mfma_f32_32x32x16_bf16 v[80:95], v[128:131], v[124:127], 0
    s_nop 11
    v_max3_f32 v4, v80, v81, v4
    v_max3_f32 v4, v82, v83, v4
    v_max3_f32 v4, v84, v85, v4
    v_max3_f32 v4, v86, v87, v4
    v_max3_f32 v4, v88, v89, v4
    v_max3_f32 v4, v90, v91, v4
    v_max3_f32 v4, v92, v93, v4
    v_max3_f32 v4, v94, v95, v4
    s_add_u32 s56, s56, 2048
    s_sub_u32 s57, s57, 1
    s_cmp_lg_u32 s57, 0
    s_cbranch_scc1 L_fb_max1
    v_mov_b32 v96, v4
    s_nop 1
    v_permlane32_swap_b32 v4, v96
    s_nop 1
    v_max_f32 v4, v4, v96
    s_sub_u32 s56, s56, 131072
    s_mov_b32 s57, 64
    v_sub_f32 v96, 0, v4
    v_mov_b32 v64, 0
    v_sub_f32 v97, 0, v4
    v_mov_b32 v65, 0
    v_sub_f32 v98, 0, v4
    v_mov_b32 v66, 0
    v_sub_f32 v99, 0, v4
    v_mov_b32 v67, 0
    v_sub_f32 v100, 0, v4
    v_mov_b32 v68, 0
    v_sub_f32 v101, 0, v4
    v_mov_b32 v69, 0
    v_sub_f32 v102, 0, v4
    v_mov_b32 v70, 0
    v_sub_f32 v103, 0, v4
    v_mov_b32 v71, 0
    v_sub_f32 v104, 0, v4
    v_mov_b32 v72, 0
    v_sub_f32 v105, 0, v4
    v_mov_b32 v73, 0
    v_sub_f32 v106, 0, v4
    v_mov_b32 v74, 0
    v_sub_f32 v107, 0, v4
    v_mov_b32 v75, 0
    v_sub_f32 v108, 0, v4
    v_mov_b32 v76, 0
    v_sub_f32 v109, 0, v4
    v_mov_b32 v77, 0
    v_sub_f32 v110, 0, v4
    v_mov_b32 v78, 0
    v_sub_f32 v111, 0, v4
    v_mov_b32 v79, 0
L_fb_sum1:
    buffer_load_dwordx4 v[128:131], v13, s[40:43], s56 offen sc1
    s_mov_b64 exec, s[52:53]
    buffer_load_dwordx4 v[132:135], v14, s[40:43], s56 offen offset:1024 sc1
    buffer_load_dwordx4 v[136:139], v14, s[40:43], s56 offen offset:1536 sc1
    s_mov_b64 exec, -1
    s_waitcnt vmcnt(0)
    v_mfma_f32_32x32x16_bf16 v[80:95], v[128:131], v[124:127], v[96:111]
    s_nop 11
    v_exp_f32 v80, v80
    v_exp_f32 v81, v81
    v_exp_f32 v82, v82
    v_exp_f32 v83, v83
    v_exp_f32 v84, v84
    v_exp_f32 v85, v85
    v_exp_f32 v86, v86
    v_exp_f32 v87, v87
    v_exp_f32 v88, v88
    v_exp_f32 v89, v89
    v_exp_f32 v90, v90
    v_exp_f32 v91, v91
    v_exp_f32 v92, v92
    v_exp_f32 v93, v93
    v_exp_f32 v94, v94
    v_exp_f32 v95, v95
    s_nop 1
    v_smfmac_f32_32x32x32_bf16 v[64:79], v[132:135], v[80:87], v12
    v_smfmac_f32_32x32x32_bf16 v[64:79], v[136:139], v[88:95], v12
    s_nop 7
    s_add_u32 s56, s56, 2048
    s_sub_u32 s57, s57, 1
    s_cmp_lg_u32 s57, 0
    s_cbranch_scc1 L_fb_sum1
    s_nop 3
    v_rcp_f32 v73, v72
    s_add_u32 s58, s54, 32768
    v_mul_f32 v64, v64, v73
    v_mul_f32 v65, v65, v73
    v_mul_f32 v66, v66, v73
    v_mul_f32 v67, v67, v73
    v_mul_f32 v68, v68, v73
    v_mul_f32 v69, v69, v73
    v_mul_f32 v70, v70, v73
    v_mul_f32 v71, v71, v73
    v_cvt_pk_bf16_f32 v228, v64, v65
    v_cvt_pk_bf16_f32 v229, v66, v67
    v_cvt_pk_bf16_f32 v230, v68, v69
    v_cvt_pk_bf16_f32 v231, v70, v71
    buffer_store_dwordx4 v[228:231], v13, s[40:43], s58 offen sc1
    s_branch L_publish
.section .rodata,"a"
.p2align 6
.amdhsa_kernel gated_mix__softmax_full_mha__glu_gated_geglu__prompt_kernel
  .amdhsa_next_free_vgpr 256
  .amdhsa_next_free_sgpr 102
  .amdhsa_accum_offset 256
  .amdhsa_group_segment_fixed_size 0
  .amdhsa_kernarg_size 88
  .amdhsa_user_sgpr_count 2
  .amdhsa_user_sgpr_kernarg_segment_ptr 1
  .amdhsa_system_sgpr_workgroup_id_x 1
  .amdhsa_float_denorm_mode_32 3
.end_amdhsa_kernel
```
